```python
import torch

def _softmax(x, axis=-1):
    return torch.softmax(x, dim=axis)

def _gelu(x):
    return torch.nn.functional.gelu(x, approximate='tanh')

def _silu(x):
    return torch.nn.functional.silu(x)

def _sigmoid(x):
    return torch.sigmoid(x)

def _layernorm(x, axis=-1, eps=1e-05):
    m = x.mean(dim=axis, keepdim=True)
    v = x.var(dim=axis, keepdim=True, unbiased=False)
    return (x - m) / torch.sqrt(v + eps)

def _scatter_add(tgt, idx, src, axis=0):
    return tgt.clone().index_add_(axis, idx, src)

def _segment_sum(src, seg, n):
    out = torch.zeros((n,) + src.shape[1:], dtype=src.dtype)
    return out.index_add_(0, seg, src)

def _pad(x, pw):
    flat = tuple((v for pair in reversed(pw) for v in pair))
    return torch.nn.functional.pad(x, flat)
kernel_name = 'adaLN_cond__mha_block_cached__glu_gated_swiglu__decode'

def setup_inputs():

    _w = lambda a: (lambda t: t.to(torch.bfloat16) if t.is_floating_point() else t)(torch.as_tensor(a))

    def _A_setup():
        B, Sq, D = (1, 1, 512)
        H, Sk, Dh = (32, 65536, 128)
        return {'x': _w((lambda *s: torch.randn(*s, dtype=torch.bfloat16) * 0.1)(B, Sq, D)), 'k_cache': _w((lambda *s: torch.randn(*s, dtype=torch.bfloat16) * 1.6)(B, H, Sk, Dh)), 'v_cache': _w((lambda *s: torch.randn(*s, dtype=torch.bfloat16) * 3.2)(B, H, Sk, Dh)), 'wq': _w((lambda *s: torch.randn(*s, dtype=torch.bfloat16) * 1.6)(D, H * Dh) * D ** (-0.5)), 'wo': _w((lambda *s: torch.randn(*s, dtype=torch.bfloat16) * 3.2)(H * Dh, D) * (H * Dh) ** (-0.5))}
    _A_in = _A_setup()

    def _B_setup():
        B, S, D, F = (1, 1, 512, 1792)
        return {'x': _w((lambda *s: torch.randn(*s, dtype=torch.bfloat16) * 0.1)(B, S, D)), 'w1': _w((lambda *s: torch.randn(*s, dtype=torch.bfloat16) * 3.2)(D, F) * (2.0 / D) ** 0.5), 'w3': _w((lambda *s: torch.randn(*s, dtype=torch.bfloat16) * 3.2)(D, F) * (2.0 / D) ** 0.5), 'w2': _w((lambda *s: torch.randn(*s, dtype=torch.bfloat16) * 3.2)(F, D) * (2.0 / F) ** 0.5)}
    _B_in = _B_setup()
    return {'A_x': _A_in['x'], 'A_k_cache': _A_in['k_cache'], 'A_v_cache': _A_in['v_cache'], 'A_wq': _A_in['wq'], 'A_wo': _A_in['wo'], 'B_x': _B_in['x'], 'B_w1': _B_in['w1'], 'B_w3': _B_in['w3'], 'B_w2': _B_in['w2'], 'c': _w((lambda *s: torch.randn(*s, dtype=torch.bfloat16) * 0.2)(1, 512) * 8.0), 'w_mod': _w((lambda *s: torch.randn(*s, dtype=torch.bfloat16) * 0.2)(512, 6 * 512) * 512 ** (-0.5) * 8.0)}

def reference(A_x, A_k_cache, A_v_cache, A_wq, A_wo, B_x, B_w1, B_w3, B_w2, c, w_mod):

    def _A_ref(x, k_cache, v_cache, wq, wo):
        B, Sq, D = x.shape
        H, Dh = (32, 128)
        q = (lambda x, *d: x.permute(*d))((x @ wq).reshape(B, Sq, H, Dh), 0, 2, 1, 3)
        scores = torch.einsum('bhqd,bhkd->bhqk', q, k_cache) * Dh ** (-0.5)
        p = _softmax(scores, axis=-1)
        o = torch.einsum('bhqk,bhkd->bhqd', p, v_cache)
        return (lambda x, *d: x.permute(*d))(o, 0, 2, 1, 3).reshape(B, Sq, H * Dh) @ wo

    def _B_ref(x, w1, w3, w2):
        gate = torch.einsum('bsd,df->bsf', x, w1)
        up = torch.einsum('bsd,df->bsf', x, w3)
        h = _silu(gate) * up
        out = torch.einsum('bsf,fd->bsd', h, w2)
        return out
    x = A_x
    mod = (_silu(c) @ w_mod).reshape(c.shape[0], 6, 1, -1)
    sa, ca, ga, sb, cb, gb = (mod[:, 0].clone(), mod[:, 1].clone(), mod[:, 2].clone(), mod[:, 3].clone(), mod[:, 4].clone(), mod[:, 5].clone())
    h = _layernorm(x, axis=-1) * (1 + ca) + sa
    x = x + ga * _A_ref(h, A_k_cache, A_v_cache, A_wq, A_wo)
    h = _layernorm(x, axis=-1) * (1 + cb) + sb
    x = x + gb * _B_ref(h, B_w1, B_w3, B_w2)
    return x
```

```asm
; @launch grid=(256,1,1) block=(512,1,1) lds=66560
.amdgcn_target "amdgcn-amd-amdhsa--gfx950"
.text
.globl adaLN_cond__mha_block_cached__glu_gated_swiglu__decode_kernel
.p2align 8
.type adaLN_cond__mha_block_cached__glu_gated_swiglu__decode_kernel,@function
adaLN_cond__mha_block_cached__glu_gated_swiglu__decode_kernel:
    s_cmp_ge_u32 s2, 256
    s_cbranch_scc1 L_exit
    s_load_dwordx16 s[16:31], s[0:1], 0
    s_load_dwordx8 s[32:39], s[0:1], 64
    s_load_dwordx4 s[40:43], s[0:1], 96
    s_getpc_b64 s[86:87]
    v_lshlrev_b32 v9, 6, v0
    s_and_b32 s86, s86, 0xffffff00
    v_min_u32 v9, L_codeend-adaLN_cond__mha_block_cached__glu_gated_swiglu__decode_kernel-4, v9
    v_mov_b32 v11, s87
    v_add_co_u32 v10, vcc, s86, v9
    s_nop 1
    v_addc_co_u32 v11, vcc, 0, v11, vcc
    global_load_dword v235, v[10:11], off
    v_and_b32 v2, 63, v0
    v_lshlrev_b32 v1, 4, v2
    v_lshrrev_b32 v8, 6, v0
    s_nop 0
    v_readfirstlane_b32 s4, v8
    v_mov_b32 v238, 0
    s_mov_b32 s99, s2
    s_lshr_b32 s91, s2, 3
    s_and_b32 s3, s2, 7
    s_cmp_eq_u32 s3, 7
    s_cselect_b32 s90, 3, 0
    s_and_b32 s3, s2, 0xc7
    s_cmp_eq_u32 s3, 0x07
    s_cselect_b32 s7, 62, 0
    s_cmp_eq_u32 s3, 0x45
    s_cselect_b32 s7, -62, s7
    s_add_u32 s2, s2, s7
    s_lshr_b32 s97, s2, 3
    s_and_b32 s6, s2, 7
    s_and_b32 s5, s97, 7
    s_lshr_b32 s3, s97, 3
    s_lshr_b32 s7, s6, 1
    s_add_u32 s3, s3, s7
    s_and_b32 s3, s3, 3
    s_lshl_b32 s5, s5, 2
    s_add_u32 s5, s5, s3
    s_mul_i32 s93, s5, 256
    s_add_u32 s93, s93, 0x30000
    s_mov_b32 s88, 0x3fb8aa3b
    s_mov_b32 s89, 0x3db504f3
    s_mov_b32 s94, 0
    s_lshr_b32 s3, s2, 6
    s_lshl_b32 s3, s3, 1
    s_and_b32 s7, s2, 1
    s_add_u32 s3, s3, s7
    s_mul_i32 s98, s3, 256
    s_sub_u32 s98, s98, 32
    s_mul_i32 s7, s7, 240
    s_cmp_lt_u32 s2, 64
    s_cselect_b32 s98, s7, s98
    s_add_u32 s3, s6, 0
    s_and_b32 s3, s3, 7
    s_lshl_b32 s3, s3, 3
    s_add_u32 s3, s3, s97
    s_lshl_b32 s95, s3, 4
    s_add_u32 s96, s95, 1024
    v_lshlrev_b32 v33, 1, v0
    v_mul_u32_u24 v34, 6144, v0
    v_lshrrev_b32 v35, 3, v0
    v_and_b32 v36, 7, v0
    v_lshlrev_b32 v36, 4, v36
    s_and_b32 s3, s2, 0xc1
    s_cmp_eq_u32 s3, 0x80
    s_cselect_b32 s83, 1, s90
    s_cmp_lt_u32 s2, 64
    s_cselect_b32 s83, 1, s83
    s_cmp_eq_u32 s4, 1
    s_cselect_b32 s83, 1, s83
    s_lshl_b32 s82, s5, 24
    s_mov_b32 s10, 0x1000000
    s_mov_b32 s11, 0x20000
    s_mov_b32 s14, 0x1000000
    s_mov_b32 s15, 0x20000
    s_waitcnt lgkmcnt(0)
    s_add_u32 s8, s18, s82
    s_addc_u32 s9, s19, 0
    s_and_b32 s9, s9, 0xffff
    s_add_u32 s12, s20, s82
    s_addc_u32 s13, s21, 0
    s_and_b32 s13, s13, 0xffff
    s_load_dword s100, s[42:43], 0x800
    s_lshl_b32 s26, s5, 3
    s_add_u32 s26, s26, s6
    s_mov_b32 s27, 0
    s_mov_b32 s1, 0
    s_mov_b32 s0, 0
    s_cmp_lg_u32 s83, 0
    s_cbranch_scc1 L_slow
    s_cmp_lg_u32 s4, 0
    s_cbranch_scc1 L_fast
    s_setprio 3
L_fast:
    s_lshl_b32 s3, s4, 1
    s_add_u32 s3, s3, s98
    s_lshl_b32 s76, s3, 12
    s_add_u32 s3, s76, 4096
    buffer_load_dwordx4 v[104:107], v1, s[8:11], s76 offen offset:0 nt
    buffer_load_dwordx4 v[108:111], v1, s[8:11], s76 offen offset:1024 nt
    buffer_load_dwordx4 v[112:115], v1, s[8:11], s76 offen offset:2048 nt
    buffer_load_dwordx4 v[116:119], v1, s[8:11], s76 offen offset:3072 nt
    buffer_load_dwordx4 v[120:123], v1, s[8:11], s3 offen offset:0 nt
    buffer_load_dwordx4 v[124:127], v1, s[8:11], s3 offen offset:1024 nt
    buffer_load_dwordx4 v[128:131], v1, s[8:11], s3 offen offset:2048 nt
    buffer_load_dwordx4 v[132:135], v1, s[8:11], s3 offen offset:3072 nt
    s_add_u32 s76, s76, 0x10000
    s_add_u32 s3, s76, 4096
    buffer_load_dwordx4 v[136:139], v1, s[8:11], s76 offen offset:0 nt
    buffer_load_dwordx4 v[140:143], v1, s[8:11], s76 offen offset:1024 nt
    buffer_load_dwordx4 v[144:147], v1, s[8:11], s76 offen offset:2048 nt
    buffer_load_dwordx4 v[148:151], v1, s[8:11], s76 offen offset:3072 nt
    buffer_load_dwordx4 v[152:155], v1, s[8:11], s3 offen offset:0 nt
    buffer_load_dwordx4 v[156:159], v1, s[8:11], s3 offen offset:1024 nt
    buffer_load_dwordx4 v[160:163], v1, s[8:11], s3 offen offset:2048 nt
    buffer_load_dwordx4 v[164:167], v1, s[8:11], s3 offen offset:3072 nt
    s_add_u32 s76, s76, 0x10000
    s_add_u32 s3, s76, 4096
    buffer_load_dwordx4 v[168:171], v1, s[8:11], s76 offen offset:0 nt
    buffer_load_dwordx4 v[172:175], v1, s[8:11], s76 offen offset:1024 nt
    buffer_load_dwordx4 v[176:179], v1, s[8:11], s76 offen offset:2048 nt
    buffer_load_dwordx4 v[180:183], v1, s[8:11], s76 offen offset:3072 nt
    buffer_load_dwordx4 v[184:187], v1, s[8:11], s3 offen offset:0 nt
    buffer_load_dwordx4 v[188:191], v1, s[8:11], s3 offen offset:1024 nt
    buffer_load_dwordx4 v[192:195], v1, s[8:11], s3 offen offset:2048 nt
    buffer_load_dwordx4 v[196:199], v1, s[8:11], s3 offen offset:3072 nt
    s_add_u32 s76, s76, 0x10000
    s_add_u32 s3, s76, 4096
    buffer_load_dwordx4 v[200:203], v1, s[8:11], s76 offen offset:0 nt
    buffer_load_dwordx4 v[204:207], v1, s[8:11], s76 offen offset:1024 nt
    buffer_load_dwordx4 v[208:211], v1, s[8:11], s76 offen offset:2048 nt
    buffer_load_dwordx4 v[212:215], v1, s[8:11], s76 offen offset:3072 nt
    buffer_load_dwordx4 v[216:219], v1, s[8:11], s3 offen offset:0 nt
    buffer_load_dwordx4 v[220:223], v1, s[8:11], s3 offen offset:1024 nt
    buffer_load_dwordx4 v[224:227], v1, s[8:11], s3 offen offset:2048 nt
    buffer_load_dwordx4 v[228:231], v1, s[8:11], s3 offen offset:3072 nt
    s_add_u32 s76, s76, 0x10000
    s_add_u32 s3, s76, 4096
    buffer_load_dwordx4 v[40:43], v1, s[8:11], s76 offen offset:0 nt
    buffer_load_dwordx4 v[44:47], v1, s[8:11], s76 offen offset:1024 nt
    buffer_load_dwordx4 v[48:51], v1, s[8:11], s76 offen offset:2048 nt
    buffer_load_dwordx4 v[52:55], v1, s[8:11], s76 offen offset:3072 nt
    buffer_load_dwordx4 v[56:59], v1, s[8:11], s3 offen offset:0 nt
    buffer_load_dwordx4 v[60:63], v1, s[8:11], s3 offen offset:1024 nt
    buffer_load_dwordx4 v[64:67], v1, s[8:11], s3 offen offset:2048 nt
    buffer_load_dwordx4 v[68:71], v1, s[8:11], s3 offen offset:3072 nt
    s_add_u32 s76, s76, 0x10000
    s_add_u32 s3, s76, 4096
    buffer_load_dwordx4 v[72:75], v1, s[8:11], s76 offen offset:0 nt
    buffer_load_dwordx4 v[76:79], v1, s[8:11], s76 offen offset:1024 nt
    buffer_load_dwordx4 v[80:83], v1, s[8:11], s76 offen offset:2048 nt
    buffer_load_dwordx4 v[84:87], v1, s[8:11], s76 offen offset:3072 nt
    buffer_load_dwordx4 v[88:91], v1, s[8:11], s3 offen offset:0 nt
    buffer_load_dwordx4 v[92:95], v1, s[8:11], s3 offen offset:1024 nt
    buffer_load_dwordx4 v[96:99], v1, s[8:11], s3 offen offset:2048 nt
    buffer_load_dwordx4 v[100:103], v1, s[8:11], s3 offen offset:3072 nt
    s_mov_b32 s44, s42
    s_and_b32 s45, s43, 0xffff
    s_mov_b32 s46, 0x100000
    s_mov_b32 s47, 0x20000
    s_mov_b32 s48, s40
    s_and_b32 s49, s41, 0xffff
    s_mov_b32 s50, 0x100
    s_mov_b32 s51, 0x20000
    s_mov_b32 s52, s38
    s_and_b32 s53, s39, 0xffff
    s_mov_b32 s54, 0x400
    s_mov_b32 s55, 0x20000
    s_branch L_nobulk
L_slow:
    s_mov_b32 s60, s34
    s_and_b32 s61, s35, 0xffff
    s_mov_b32 s62, 0x400
    s_mov_b32 s63, 0x20000
    s_mov_b32 s56, s16
    s_and_b32 s57, s17, 0xffff
    s_mov_b32 s58, 0x400
    s_mov_b32 s59, 0x20000
    s_cmp_ge_u32 s2, 64
    s_cbranch_scc1 L_notP
    s_mov_b32 s64, s36
    s_and_b32 s65, s37, 0xffff
    s_mov_b32 s66, 0x300000
    s_mov_b32 s67, 0x20000
    v_mul_u32_u24 v34, 6144, v35
    v_add_u32 v34, v34, v36
    s_mul_i32 s3, s6, 393216
    s_lshl_b32 s7, s97, 7
    s_add_u32 s3, s3, s7
    buffer_load_dwordx4 v[24:27], v34, s[64:67], s3 offen nt
    buffer_load_dwordx4 v[28:31], v34, s[64:67], s3 offen offset:1024 nt
    v_lshlrev_b32 v37, 1, v35
    s_lshl_b32 s3, s6, 7
    buffer_load_ushort v32, v37, s[60:63], s3 offen
    buffer_load_dwordx4 v[72:75], v1, s[56:59], 0 offen
    buffer_load_ushort v76, v33, s[56:59], 0 offen
    s_mov_b32 s68, s22
    s_and_b32 s69, s23, 0xffff
    s_mov_b32 s70, 0x400000
    s_mov_b32 s71, 0x20000
    v_lshl_add_u32 v37, v35, 16, v36
    s_lshl_b32 s3, s2, 7
    buffer_load_dwordx4 v[40:43], v37, s[68:71], s3 offen nt
    s_add_u32 s3, s3, 0x2000
    buffer_load_dwordx4 v[44:47], v37, s[68:71], s3 offen nt
    s_add_u32 s3, s3, 0x2000
    buffer_load_dwordx4 v[48:51], v37, s[68:71], s3 offen nt
    s_add_u32 s3, s3, 0x2000
    buffer_load_dwordx4 v[52:55], v37, s[68:71], s3 offen nt
    s_add_u32 s3, s3, 0x2000
    buffer_load_dwordx4 v[56:59], v37, s[68:71], s3 offen nt
    s_add_u32 s3, s3, 0x2000
    buffer_load_dwordx4 v[60:63], v37, s[68:71], s3 offen nt
    s_add_u32 s3, s3, 0x2000
    buffer_load_dwordx4 v[64:67], v37, s[68:71], s3 offen nt
    s_add_u32 s3, s3, 0x2000
    buffer_load_dwordx4 v[68:71], v37, s[68:71], s3 offen nt
    s_mov_b32 s44, s42
    s_and_b32 s45, s43, 0xffff
    s_mov_b32 s46, 0x100000
    s_mov_b32 s47, 0x20000
    s_mov_b32 s48, s40
    s_and_b32 s49, s41, 0xffff
    s_mov_b32 s50, 0x100
    s_mov_b32 s51, 0x20000
    s_mov_b32 s52, s38
    s_and_b32 s53, s39, 0xffff
    s_mov_b32 s54, 0x400
    s_mov_b32 s55, 0x20000
    s_mov_b32 s90, 1
    s_mov_b32 s91, 0
    s_cmp_lg_u32 s4, 0
    s_cbranch_scc1 L_P1
    s_setprio 3
L_P1:
    s_nop 4
    v_lshrrev_b32 v38, 5, v0
    v_lshlrev_b32 v38, 8, v38
    v_lshl_add_u32 v38, v36, 1, v38
    v_and_b32 v39, 16, v0
    v_add_u32 v38, v38, v39
    v_lshlrev_b32 v39, 2, v2
    v_add_u32 v39, 0x2000, v39
    s_lshl_b32 s95, s97, 13
    s_lshl_b32 s3, s6, 10
    s_add_u32 s95, s95, s3
    s_add_u32 s95, s95, 0x60000
    s_lshl_b32 s96, s4, 13
    s_add_u32 s96, s96, 0x60000
    s_add_u32 s83, s96, 4096
    s_waitcnt vmcnt(10)
    v_lshlrev_b32 v32, 16, v32
    v_mul_f32 v34, s88, v32
    v_exp_f32 v34, -v34
    s_nop 0
    v_min_f32 v34, 0x7f000000, v34
    v_add_f32 v34, 1.0, v34
    v_rcp_f32 v35, v34
    s_nop 0
    v_mul_f32 v33, v32, v35
    v_fma_f32 v36, -v33, v34, v32
    v_fmac_f32 v33, v36, v35
    v_cvt_pk_bf16_f32 v34, 0, v33
    v_cvt_pk_bf16_f32 v35, v33, 0
    v_dot2_f32_bf16 v8, v24, v35, 0
    v_dot2_f32_bf16 v9, v24, v34, 0
    v_dot2_f32_bf16 v10, v25, v35, 0
    v_dot2_f32_bf16 v11, v25, v34, 0
    v_dot2_f32_bf16 v12, v26, v35, 0
    v_dot2_f32_bf16 v13, v26, v34, 0
    v_dot2_f32_bf16 v14, v27, v35, 0
    v_dot2_f32_bf16 v15, v27, v34, 0
    v_dot2_f32_bf16 v16, v28, v35, 0
    v_dot2_f32_bf16 v17, v28, v34, 0
    v_dot2_f32_bf16 v18, v29, v35, 0
    v_dot2_f32_bf16 v19, v29, v34, 0
    v_dot2_f32_bf16 v20, v30, v35, 0
    v_dot2_f32_bf16 v21, v30, v34, 0
    v_dot2_f32_bf16 v22, v31, v35, 0
    v_dot2_f32_bf16 v23, v31, v34, 0
    v_permlane32_swap_b32 v8, v16
    v_permlane32_swap_b32 v9, v17
    v_permlane32_swap_b32 v10, v18
    v_permlane32_swap_b32 v11, v19
    v_permlane32_swap_b32 v12, v20
    v_permlane32_swap_b32 v13, v21
    v_permlane32_swap_b32 v14, v22
    v_permlane32_swap_b32 v15, v23
    v_add_f32 v8, v8, v16
    v_add_f32 v9, v9, v17
    v_add_f32 v10, v10, v18
    v_add_f32 v11, v11, v19
    v_add_f32 v12, v12, v20
    v_add_f32 v13, v13, v21
    v_add_f32 v14, v14, v22
    v_add_f32 v15, v15, v23
    v_permlane16_swap_b32 v8, v12
    v_permlane16_swap_b32 v9, v13
    v_permlane16_swap_b32 v10, v14
    v_permlane16_swap_b32 v11, v15
    v_add_f32 v8, v8, v12
    v_add_f32 v9, v9, v13
    v_add_f32 v10, v10, v14
    v_add_f32 v11, v11, v15
    v_add_f32_dpp v8, v8, v8 row_ror:8 row_mask:0xf bank_mask:0xf
    v_add_f32_dpp v9, v9, v9 row_ror:8 row_mask:0xf bank_mask:0xf
    v_add_f32_dpp v10, v10, v10 row_ror:8 row_mask:0xf bank_mask:0xf
    v_add_f32_dpp v11, v11, v11 row_ror:8 row_mask:0xf bank_mask:0xf
    ds_write_b128 v38, v[8:11] offset:8192
    s_waitcnt lgkmcnt(0)
    s_barrier
    s_mul_i32 s100, s100, 0x41c64e6d
    s_add_u32 s100, s100, 0x3039
    s_cmp_lg_u32 s4, 0
    s_cbranch_scc1 L_P2
    ds_read2st64_b32 v[8:9], v39 offset0:0 offset1:1
    ds_read2st64_b32 v[10:11], v39 offset0:2 offset1:3
    ds_read2st64_b32 v[12:13], v39 offset0:4 offset1:5
    ds_read2st64_b32 v[14:15], v39 offset0:6 offset1:7
    ds_read2st64_b32 v[16:17], v39 offset0:8 offset1:9
    ds_read2st64_b32 v[18:19], v39 offset0:10 offset1:11
    ds_read2st64_b32 v[20:21], v39 offset0:12 offset1:13
    ds_read2st64_b32 v[22:23], v39 offset0:14 offset1:15
    s_waitcnt lgkmcnt(0)
    v_pk_add_f32 v[8:9], v[8:9], v[16:17]
    v_pk_add_f32 v[10:11], v[10:11], v[18:19]
    v_pk_add_f32 v[12:13], v[12:13], v[20:21]
    v_pk_add_f32 v[14:15], v[14:15], v[22:23]
    v_pk_add_f32 v[8:9], v[8:9], v[12:13]
    v_pk_add_f32 v[10:11], v[10:11], v[14:15]
    v_pk_add_f32 v[8:9], v[8:9], v[10:11]
    v_mov_b32 v10, v9
    v_mov_b32 v9, s100
    v_mov_b32 v11, s100
    buffer_store_dwordx4 v[8:11], v1, s[44:47], s95 offen sc1
L_P2:
    s_nop 4
    s_waitcnt vmcnt(8)
    v_lshlrev_b32 v80, 16, v72
    v_and_b32 v81, 0xffff0000, v72
    v_lshlrev_b32 v82, 16, v73
    v_and_b32 v83, 0xffff0000, v73
    v_lshlrev_b32 v84, 16, v74
    v_and_b32 v85, 0xffff0000, v74
    v_lshlrev_b32 v86, 16, v75
    v_and_b32 v87, 0xffff0000, v75
    v_readfirstlane_b32 s76, v80
    s_mov_b32 s84, 0x3b000000
    s_nop 0
    v_pk_add_f32 v[80:81], v[80:81], s[76:77] op_sel_hi:[1,0] neg_lo:[0,1] neg_hi:[0,1]
    v_pk_add_f32 v[82:83], v[82:83], s[76:77] op_sel_hi:[1,0] neg_lo:[0,1] neg_hi:[0,1]
    v_pk_add_f32 v[84:85], v[84:85], s[76:77] op_sel_hi:[1,0] neg_lo:[0,1] neg_hi:[0,1]
    v_pk_add_f32 v[86:87], v[86:87], s[76:77] op_sel_hi:[1,0] neg_lo:[0,1] neg_hi:[0,1]
    v_pk_mul_f32 v[92:93], v[80:81], v[80:81]
    v_pk_fma_f32 v[92:93], v[82:83], v[82:83], v[92:93]
    v_pk_fma_f32 v[92:93], v[84:85], v[84:85], v[92:93]
    v_pk_fma_f32 v[92:93], v[86:87], v[86:87], v[92:93]
    v_pk_add_f32 v[80:81], v[80:81], v[82:83]
    v_pk_add_f32 v[84:85], v[84:85], v[86:87]
    v_add_f32 v89, v92, v93
    v_pk_add_f32 v[80:81], v[80:81], v[84:85]
    v_add_f32 v88, v80, v81
    s_nop 1
    v_add_f32_dpp v88, v88, v88 row_ror:8 row_mask:0xf bank_mask:0xf
    v_add_f32_dpp v89, v89, v89 row_ror:8 row_mask:0xf bank_mask:0xf
    s_nop 0
    v_add_f32_dpp v88, v88, v88 row_ror:4 row_mask:0xf bank_mask:0xf
    v_add_f32_dpp v89, v89, v89 row_ror:4 row_mask:0xf bank_mask:0xf
    s_nop 0
    v_add_f32_dpp v88, v88, v88 row_ror:2 row_mask:0xf bank_mask:0xf
    v_add_f32_dpp v89, v89, v89 row_ror:2 row_mask:0xf bank_mask:0xf
    s_nop 0
    v_add_f32_dpp v88, v88, v88 row_ror:1 row_mask:0xf bank_mask:0xf
    v_add_f32_dpp v89, v89, v89 row_ror:1 row_mask:0xf bank_mask:0xf
    s_nop 1
    v_permlane32_swap_b32 v88, v89
    v_add_f32 v88, v88, v89
    v_mov_b32 v89, v88
    s_nop 1
    v_permlane16_swap_b32 v88, v89
    v_add_f32 v88, v88, v89
    v_mov_b32 v89, v88
    s_nop 1
    v_permlane32_swap_b32 v88, v89
    v_mul_f32 v88, 0x3b000000, v88
    v_mul_f32 v91, v88, v88
    v_add_f32 v88, s76, v88
    v_fma_f32 v89, v89, s84, -v91
    v_max_f32 v89, 0, v89
    v_cvt_pk_bf16_f32 v89, 0, v89
    v_add_f32 v89, 0x3727c5ac, v89
    v_cvt_pk_bf16_f32 v89, 0, v89
    v_sqrt_f32 v89, v89
    s_nop 0
    v_cvt_pk_bf16_f32 v89, 0, v89
    v_rcp_f32 v90, v89
    v_cvt_pk_bf16_f32 v88, 0, v88
    v_lshlrev_b32 v76, 16, v76
    v_sub_f32 v96, v76, v88
    v_cvt_pk_bf16_f32 v96, 0, v96
    v_mul_f32 v95, v96, v90
    v_fma_f32 v97, -v95, v89, v96
    v_fmac_f32 v95, v97, v90
    v_cvt_pk_bf16_f32 v95, 0, v95
    v_lshlrev_b32 v36, 2, v0
L_ph:
    s_nop 4
    buffer_load_dwordx4 v[104:107], v1, s[44:47], s96 offen offset:0 sc1
    buffer_load_dwordx4 v[108:111], v1, s[44:47], s96 offen offset:1024 sc1
    buffer_load_dwordx4 v[112:115], v1, s[44:47], s96 offen offset:2048 sc1
    buffer_load_dwordx4 v[116:119], v1, s[44:47], s96 offen offset:3072 sc1
    buffer_load_dwordx4 v[120:123], v1, s[44:47], s83 offen offset:0 sc1
    buffer_load_dwordx4 v[124:127], v1, s[44:47], s83 offen offset:1024 sc1
    buffer_load_dwordx4 v[128:131], v1, s[44:47], s83 offen offset:2048 sc1
    buffer_load_dwordx4 v[132:135], v1, s[44:47], s83 offen offset:3072 sc1
    s_waitcnt vmcnt(0)
    v_xor_b32 v34, s100, v105
    v_xor_b32 v35, s100, v107
    v_bitop3_b32 v34, v34, v109, s100 bitop3:0xf6
    v_bitop3_b32 v35, v35, v111, s100 bitop3:0xf6
    v_bitop3_b32 v34, v34, v113, s100 bitop3:0xf6
    v_bitop3_b32 v35, v35, v115, s100 bitop3:0xf6
    v_bitop3_b32 v34, v34, v117, s100 bitop3:0xf6
    v_bitop3_b32 v35, v35, v119, s100 bitop3:0xf6
    v_bitop3_b32 v34, v34, v121, s100 bitop3:0xf6
    v_bitop3_b32 v35, v35, v123, s100 bitop3:0xf6
    v_bitop3_b32 v34, v34, v125, s100 bitop3:0xf6
    v_bitop3_b32 v35, v35, v127, s100 bitop3:0xf6
    v_bitop3_b32 v34, v34, v129, s100 bitop3:0xf6
    v_bitop3_b32 v35, v35, v131, s100 bitop3:0xf6
    v_bitop3_b32 v34, v34, v133, s100 bitop3:0xf6
    v_bitop3_b32 v35, v35, v135, s100 bitop3:0xf6
    v_or_b32 v34, v34, v35
    v_cmp_ne_u32 vcc, 0, v34
    s_cbranch_vccz L_ph_ok
    s_add_u32 s94, s94, 1
    s_cmp_lt_u32 s94, 0x40000
    s_cbranch_scc1 L_ph
    s_branch L_end
L_ph_ok:
    s_nop 4
    v_add_f32 v104, v104, v120
    v_add_f32 v106, v106, v122
    v_add_f32 v108, v108, v124
    v_add_f32 v110, v110, v126
    v_add_f32 v112, v112, v128
    v_add_f32 v114, v114, v130
    v_add_f32 v116, v116, v132
    v_add_f32 v118, v118, v134
    v_add_f32 v104, v104, v112
    v_add_f32 v106, v106, v114
    v_add_f32 v108, v108, v116
    v_add_f32 v110, v110, v118
    v_add_f32 v104, v104, v108
    v_add_f32 v106, v106, v110
    v_cvt_pk_bf16_f32 v104, 0, v104
    v_cvt_pk_bf16_f32 v106, 0, v106
    v_add_f32 v106, 1.0, v106
    v_cvt_pk_bf16_f32 v106, 0, v106
    v_mul_f32 v95, v95, v106
    v_cvt_pk_bf16_f32 v95, 0, v95
    v_add_f32 v95, v95, v104
    v_cvt_pk_bf16_f32 v95, 0, v95
    ds_write_b32 v36, v95 offset:2048
    s_waitcnt lgkmcnt(0)
    v_lshrrev_b32 v8, 3, v0
    v_lshlrev_b32 v8, 5, v8
    ds_read_b128 v[16:19], v8 offset:2048
    ds_read_b128 v[20:23], v8 offset:2064
    v_and_b32 v9, 7, v0
    v_lshlrev_b32 v9, 5, v9
    v_bfe_u32 v10, v0, 4, 2
    v_lshl_add_u32 v9, v10, 3, v9
    v_lshrrev_b32 v10, 6, v0
    v_lshl_add_u32 v9, v10, 8, v9
    s_waitcnt lgkmcnt(0)
    v_lshrrev_b32 v12, 16, v16
    v_lshrrev_b32 v13, 16, v17
    v_lshrrev_b32 v14, 16, v18
    v_lshrrev_b32 v15, 16, v19
    v_dot2_f32_bf16 v24, v40, v12, 0
    v_dot2_f32_bf16 v25, v40, v16, 0
    v_dot2_f32_bf16 v26, v41, v12, 0
    v_dot2_f32_bf16 v27, v41, v16, 0
    v_dot2_f32_bf16 v28, v42, v12, 0
    v_dot2_f32_bf16 v29, v42, v16, 0
    v_dot2_f32_bf16 v30, v43, v12, 0
    v_dot2_f32_bf16 v31, v43, v16, 0
    v_lshrrev_b32 v12, 16, v20
    v_dot2_f32_bf16 v24, v44, v13, v24
    v_dot2_f32_bf16 v25, v44, v17, v25
    v_dot2_f32_bf16 v26, v45, v13, v26
    v_dot2_f32_bf16 v27, v45, v17, v27
    v_dot2_f32_bf16 v28, v46, v13, v28
    v_dot2_f32_bf16 v29, v46, v17, v29
    v_dot2_f32_bf16 v30, v47, v13, v30
    v_dot2_f32_bf16 v31, v47, v17, v31
    v_lshrrev_b32 v13, 16, v21
    v_dot2_f32_bf16 v24, v48, v14, v24
    v_dot2_f32_bf16 v25, v48, v18, v25
    v_dot2_f32_bf16 v26, v49, v14, v26
    v_dot2_f32_bf16 v27, v49, v18, v27
    v_dot2_f32_bf16 v28, v50, v14, v28
    v_dot2_f32_bf16 v29, v50, v18, v29
    v_dot2_f32_bf16 v30, v51, v14, v30
    v_dot2_f32_bf16 v31, v51, v18, v31
    v_lshrrev_b32 v14, 16, v22
    v_dot2_f32_bf16 v24, v52, v15, v24
    v_dot2_f32_bf16 v25, v52, v19, v25
    v_dot2_f32_bf16 v26, v53, v15, v26
    v_dot2_f32_bf16 v27, v53, v19, v27
    v_dot2_f32_bf16 v28, v54, v15, v28
    v_dot2_f32_bf16 v29, v54, v19, v29
    v_dot2_f32_bf16 v30, v55, v15, v30
    v_dot2_f32_bf16 v31, v55, v19, v31
    v_lshrrev_b32 v15, 16, v23
    v_dot2_f32_bf16 v24, v56, v12, v24
    v_dot2_f32_bf16 v25, v56, v20, v25
    v_dot2_f32_bf16 v26, v57, v12, v26
    v_dot2_f32_bf16 v27, v57, v20, v27
    v_dot2_f32_bf16 v28, v58, v12, v28
    v_dot2_f32_bf16 v29, v58, v20, v29
    v_dot2_f32_bf16 v30, v59, v12, v30
    v_dot2_f32_bf16 v31, v59, v20, v31
    v_dot2_f32_bf16 v24, v60, v13, v24
    v_dot2_f32_bf16 v25, v60, v21, v25
    v_dot2_f32_bf16 v26, v61, v13, v26
    v_dot2_f32_bf16 v27, v61, v21, v27
    v_dot2_f32_bf16 v28, v62, v13, v28
    v_dot2_f32_bf16 v29, v62, v21, v29
    v_dot2_f32_bf16 v30, v63, v13, v30
    v_dot2_f32_bf16 v31, v63, v21, v31
    v_dot2_f32_bf16 v24, v64, v14, v24
    v_dot2_f32_bf16 v25, v64, v22, v25
    v_dot2_f32_bf16 v26, v65, v14, v26
    v_dot2_f32_bf16 v27, v65, v22, v27
    v_dot2_f32_bf16 v28, v66, v14, v28
    v_dot2_f32_bf16 v29, v66, v22, v29
    v_dot2_f32_bf16 v30, v67, v14, v30
    v_dot2_f32_bf16 v31, v67, v22, v31
    v_dot2_f32_bf16 v24, v68, v15, v24
    v_dot2_f32_bf16 v25, v68, v23, v25
    v_dot2_f32_bf16 v26, v69, v15, v26
    v_dot2_f32_bf16 v27, v69, v23, v27
    v_dot2_f32_bf16 v28, v70, v15, v28
    v_dot2_f32_bf16 v29, v70, v23, v29
    v_dot2_f32_bf16 v30, v71, v15, v30
    v_dot2_f32_bf16 v31, v71, v23, v31
    v_permlane32_swap_b32 v24, v28
    v_permlane32_swap_b32 v25, v29
    v_permlane32_swap_b32 v26, v30
    v_permlane32_swap_b32 v27, v31
    v_add_f32 v24, v24, v28
    v_add_f32 v25, v25, v29
    v_add_f32 v26, v26, v30
    v_add_f32 v27, v27, v31
    s_nop 0
    v_permlane16_swap_b32 v24, v26
    v_permlane16_swap_b32 v25, v27
    v_add_f32 v24, v24, v26
    v_add_f32 v25, v25, v27
    s_nop 0
    v_add_f32_dpp v24, v24, v24 row_ror:8 row_mask:0xf bank_mask:0xf
    v_add_f32_dpp v25, v25, v25 row_ror:8 row_mask:0xf bank_mask:0xf
    ds_write_b64 v9, v[24:25] offset:6144
    s_waitcnt lgkmcnt(0)
    s_barrier
    s_cmp_lg_u32 s4, 0
    s_cbranch_scc1 L_P4
    v_and_b32 v73, 63, v2
    v_lshlrev_b32 v73, 2, v73
    ds_read_b32 v80, v73 offset:6144
    ds_read_b32 v81, v73 offset:6400
    ds_read_b32 v82, v73 offset:6656
    ds_read_b32 v83, v73 offset:6912
    ds_read_b32 v84, v73 offset:7168
    ds_read_b32 v85, v73 offset:7424
    ds_read_b32 v86, v73 offset:7680
    ds_read_b32 v87, v73 offset:7936
    s_waitcnt lgkmcnt(0)
    v_add_f32 v80, v80, v84
    v_add_f32 v81, v81, v85
    v_add_f32 v82, v82, v86
    v_add_f32 v83, v83, v87
    v_add_f32 v80, v80, v82
    v_add_f32 v81, v81, v83
    v_add_f32 v72, v80, v81
    s_lshl_b32 s3, s2, 8
    s_add_u32 s3, s3, 0xc000
    v_mov_b32_dpp v76, v72 quad_perm:[1,1,3,3] row_mask:0xf bank_mask:0xf
    v_cvt_pk_bf16_f32 v74, v72, v76
    v_mov_b32 v75, s100
    v_lshlrev_b32 v76, 2, v2
    s_mov_b32 exec_lo, 0x55555555
    s_mov_b32 exec_hi, 0x55555555
    buffer_store_dwordx2 v[74:75], v76, s[44:47], s3 offen sc1
    s_mov_b64 exec, -1
    s_barrier
    s_branch L_notM2
L_P4:
    s_nop 4
    s_barrier
    s_cmp_lg_u32 s4, 1
    s_cbranch_scc1 L_P5
    v_mov_b32 v36, -1
    v_mov_b32 v37, -1
    v_mov_b32 v38, -1
    v_mov_b32 v39, -1
    v_mov_b32 v34, 0
    v_mov_b32 v35, 0
    s_lshl_b32 s3, s26, 9
    s_add_u32 s3, s3, 0x10000
    s_mov_b32 exec_hi, 0
    buffer_store_dwordx4 v[36:39], v1, s[44:47], s3 offen sc1
    s_lshl_b32 s3, s2, 8
    s_add_u32 s3, s3, 0x4000
    s_cmp_lt_u32 s2, 96
    s_cselect_b32 s3, s3, 0x7f000000
    s_mov_b64 exec, 0xffff
    buffer_store_dwordx4 v[36:39], v1, s[44:47], s3 offen sc1
    s_lshl_b32 s3, s26, 7
    s_add_u32 s3, s3, 0x38000
    s_mov_b64 exec, 1
    buffer_store_dwordx2 v[36:37], v34, s[44:47], s3 offen sc1
    s_cmp_eq_u32 s6, 0
    s_cselect_b32 s3, s93, 0x7f000000
    buffer_store_dwordx2 v[34:35], v34, s[44:47], s3 offen sc1
    s_mov_b64 exec, -1
L_P5:
    s_nop 4
    s_lshl_b32 s3, s4, 1
    s_add_u32 s3, s3, s98
    s_lshl_b32 s76, s3, 12
    s_add_u32 s3, s76, 4096
    buffer_load_dwordx4 v[104:107], v1, s[8:11], s76 offen offset:0 nt
    buffer_load_dwordx4 v[108:111], v1, s[8:11], s76 offen offset:1024 nt
    buffer_load_dwordx4 v[112:115], v1, s[8:11], s76 offen offset:2048 nt
    buffer_load_dwordx4 v[116:119], v1, s[8:11], s76 offen offset:3072 nt
    buffer_load_dwordx4 v[120:123], v1, s[8:11], s3 offen offset:0 nt
    buffer_load_dwordx4 v[124:127], v1, s[8:11], s3 offen offset:1024 nt
    buffer_load_dwordx4 v[128:131], v1, s[8:11], s3 offen offset:2048 nt
    buffer_load_dwordx4 v[132:135], v1, s[8:11], s3 offen offset:3072 nt
    s_add_u32 s76, s76, 0x10000
    s_add_u32 s3, s76, 4096
    buffer_load_dwordx4 v[136:139], v1, s[8:11], s76 offen offset:0 nt
    buffer_load_dwordx4 v[140:143], v1, s[8:11], s76 offen offset:1024 nt
    buffer_load_dwordx4 v[144:147], v1, s[8:11], s76 offen offset:2048 nt
    buffer_load_dwordx4 v[148:151], v1, s[8:11], s76 offen offset:3072 nt
    buffer_load_dwordx4 v[152:155], v1, s[8:11], s3 offen offset:0 nt
    buffer_load_dwordx4 v[156:159], v1, s[8:11], s3 offen offset:1024 nt
    buffer_load_dwordx4 v[160:163], v1, s[8:11], s3 offen offset:2048 nt
    buffer_load_dwordx4 v[164:167], v1, s[8:11], s3 offen offset:3072 nt
    s_add_u32 s76, s76, 0x10000
    s_add_u32 s3, s76, 4096
    buffer_load_dwordx4 v[168:171], v1, s[8:11], s76 offen offset:0 nt
    buffer_load_dwordx4 v[172:175], v1, s[8:11], s76 offen offset:1024 nt
    buffer_load_dwordx4 v[176:179], v1, s[8:11], s76 offen offset:2048 nt
    buffer_load_dwordx4 v[180:183], v1, s[8:11], s76 offen offset:3072 nt
    buffer_load_dwordx4 v[184:187], v1, s[8:11], s3 offen offset:0 nt
    buffer_load_dwordx4 v[188:191], v1, s[8:11], s3 offen offset:1024 nt
    buffer_load_dwordx4 v[192:195], v1, s[8:11], s3 offen offset:2048 nt
    buffer_load_dwordx4 v[196:199], v1, s[8:11], s3 offen offset:3072 nt
    s_add_u32 s76, s76, 0x10000
    s_add_u32 s3, s76, 4096
    buffer_load_dwordx4 v[200:203], v1, s[8:11], s76 offen offset:0 nt
    buffer_load_dwordx4 v[204:207], v1, s[8:11], s76 offen offset:1024 nt
    buffer_load_dwordx4 v[208:211], v1, s[8:11], s76 offen offset:2048 nt
    buffer_load_dwordx4 v[212:215], v1, s[8:11], s76 offen offset:3072 nt
    buffer_load_dwordx4 v[216:219], v1, s[8:11], s3 offen offset:0 nt
    buffer_load_dwordx4 v[220:223], v1, s[8:11], s3 offen offset:1024 nt
    buffer_load_dwordx4 v[224:227], v1, s[8:11], s3 offen offset:2048 nt
    buffer_load_dwordx4 v[228:231], v1, s[8:11], s3 offen offset:3072 nt
    s_add_u32 s76, s76, 0x10000
    s_add_u32 s3, s76, 4096
    buffer_load_dwordx4 v[72:75], v1, s[8:11], s76 offen offset:0 nt
    buffer_load_dwordx4 v[76:79], v1, s[8:11], s76 offen offset:1024 nt
    buffer_load_dwordx4 v[80:83], v1, s[8:11], s76 offen offset:2048 nt
    buffer_load_dwordx4 v[84:87], v1, s[8:11], s76 offen offset:3072 nt
    buffer_load_dwordx4 v[88:91], v1, s[8:11], s3 offen offset:0 nt
    buffer_load_dwordx4 v[92:95], v1, s[8:11], s3 offen offset:1024 nt
    buffer_load_dwordx4 v[96:99], v1, s[8:11], s3 offen offset:2048 nt
    buffer_load_dwordx4 v[100:103], v1, s[8:11], s3 offen offset:3072 nt
    s_branch L_waitq
L_notP:
    s_nop 4
    s_mov_b32 s44, s42
    s_and_b32 s45, s43, 0xffff
    s_mov_b32 s46, 0x100000
    s_mov_b32 s47, 0x20000
    s_mov_b32 s48, s40
    s_and_b32 s49, s41, 0xffff
    s_mov_b32 s50, 0x100
    s_mov_b32 s51, 0x20000
    s_mov_b32 s52, s38
    s_and_b32 s53, s39, 0xffff
    s_mov_b32 s54, 0x400
    s_mov_b32 s55, 0x20000
    s_cmp_lg_u32 s4, 0
    s_cbranch_scc1 L_N1
    s_setprio 3
L_N1:
    s_nop 4
    s_cmp_eq_u32 s90, 3
    s_cbranch_scc1 L_isT
    s_and_b32 s3, s2, 0xc1
    s_cmp_lg_u32 s3, 0x80
    s_cbranch_scc1 L_N2
    s_mov_b32 s90, 2
    s_bfe_u32 s91, s2, 0x50001
    buffer_load_ushort v32, v33, s[60:63], 0 offen
    s_mov_b32 s68, s36
    s_and_b32 s69, s37, 0xffff
    s_mov_b32 s70, 0x300000
    s_mov_b32 s71, 0x20000
    v_mul_u32_u24 v37, 49152, v35
    v_add_u32 v37, v37, v36
    s_lshl_b32 s3, s91, 7
    s_add_u32 s3, s3, 2048
    buffer_load_dwordx4 v[40:43], v37, s[68:71], s3 offen nt
    s_add_u32 s3, s3, 0x1800
    buffer_load_dwordx4 v[44:47], v37, s[68:71], s3 offen nt
    s_add_u32 s3, s3, 0x1800
    buffer_load_dwordx4 v[48:51], v37, s[68:71], s3 offen nt
    s_add_u32 s3, s3, 0x1800
    buffer_load_dwordx4 v[52:55], v37, s[68:71], s3 offen nt
    s_add_u32 s3, s3, 0x1800
    buffer_load_dwordx4 v[56:59], v37, s[68:71], s3 offen nt
    s_add_u32 s3, s3, 0x1800
    buffer_load_dwordx4 v[60:63], v37, s[68:71], s3 offen nt
    s_add_u32 s3, s3, 0x1800
    buffer_load_dwordx4 v[64:67], v37, s[68:71], s3 offen nt
    s_add_u32 s3, s3, 0x1800
    buffer_load_dwordx4 v[68:71], v37, s[68:71], s3 offen nt
    s_branch L_N2
L_isT:
    s_nop 4
    buffer_load_ushort v3, v33, s[56:59], 0 offen
    s_getreg_b32 s3, hwreg(HW_REG_XCC_ID)
    s_and_b32 s3, s3, 15
    s_mul_i32 s7, s3, s3
    s_lshl_b32 s3, s3, 10
    s_lshl_b32 s7, s7, 19
    s_add_u32 s1, s3, s7
    s_cmp_lg_u32 s4, 1
    s_cbranch_scc1 L_T1
    v_mov_b32 v36, -1
    v_mov_b32 v37, -1
    v_mov_b32 v38, -1
    v_mov_b32 v39, -1
    v_mov_b32 v34, 0
    v_mov_b32 v35, 0
    s_lshl_b32 s3, s26, 9
    s_add_u32 s3, s3, 0x10000
    s_mov_b32 exec_hi, 0
    buffer_store_dwordx4 v[36:39], v1, s[44:47], s3 offen sc1
    s_lshl_b32 s3, s2, 8
    s_add_u32 s3, s3, 0x4000
    s_cmp_lt_u32 s2, 96
    s_cselect_b32 s3, s3, 0x7f000000
    s_mov_b64 exec, 0xffff
    buffer_store_dwordx4 v[36:39], v1, s[44:47], s3 offen sc1
    s_lshl_b32 s3, s26, 7
    s_add_u32 s3, s3, 0x38000
    s_mov_b64 exec, 1
    buffer_store_dwordx2 v[36:37], v34, s[44:47], s3 offen sc1
    s_cmp_eq_u32 s6, 0
    s_cselect_b32 s3, s93, 0x7f000000
    buffer_store_dwordx2 v[34:35], v34, s[44:47], s3 offen sc1
    s_mov_b64 exec, -1
L_T1:
    s_nop 4
    s_mov_b32 s68, s24
    s_and_b32 s69, s25, 0xffff
    s_mov_b32 s70, 0x400000
    s_mov_b32 s71, 0x20000
    v_lshrrev_b32 v35, 4, v0
    v_and_b32 v36, 15, v0
    v_lshlrev_b32 v36, 4, v36
    v_lshl_add_u32 v37, v35, 14, v36
    s_lshr_b32 s3, s91, 2
    s_lshl_b32 s3, s3, 19
    s_and_b32 s7, s91, 3
    s_lshl_b32 s7, s7, 8
    s_add_u32 s3, s3, s7
    buffer_load_dwordx4 v[104:107], v37, s[68:71], s3 offen nt
    s_add_u32 s3, s3, 0x400
    buffer_load_dwordx4 v[108:111], v37, s[68:71], s3 offen nt
    s_add_u32 s3, s3, 0x400
    buffer_load_dwordx4 v[112:115], v37, s[68:71], s3 offen nt
    s_add_u32 s3, s3, 0x400
    buffer_load_dwordx4 v[116:119], v37, s[68:71], s3 offen nt
    s_add_u32 s3, s3, 0x400
    buffer_load_dwordx4 v[120:123], v37, s[68:71], s3 offen nt
    s_add_u32 s3, s3, 0x400
    buffer_load_dwordx4 v[124:127], v37, s[68:71], s3 offen nt
    s_add_u32 s3, s3, 0x400
    buffer_load_dwordx4 v[128:131], v37, s[68:71], s3 offen nt
    s_add_u32 s3, s3, 0x400
    buffer_load_dwordx4 v[132:135], v37, s[68:71], s3 offen nt
    s_add_u32 s3, s3, 0x400
    buffer_load_dwordx4 v[136:139], v37, s[68:71], s3 offen nt
    s_add_u32 s3, s3, 0x400
    buffer_load_dwordx4 v[140:143], v37, s[68:71], s3 offen nt
    s_add_u32 s3, s3, 0x400
    buffer_load_dwordx4 v[144:147], v37, s[68:71], s3 offen nt
    s_add_u32 s3, s3, 0x400
    buffer_load_dwordx4 v[148:151], v37, s[68:71], s3 offen nt
    s_add_u32 s3, s3, 0x400
    buffer_load_dwordx4 v[152:155], v37, s[68:71], s3 offen nt
    s_add_u32 s3, s3, 0x400
    buffer_load_dwordx4 v[156:159], v37, s[68:71], s3 offen nt
    s_add_u32 s3, s3, 0x400
    buffer_load_dwordx4 v[160:163], v37, s[68:71], s3 offen nt
    s_add_u32 s3, s3, 0x400
    buffer_load_dwordx4 v[164:167], v37, s[68:71], s3 offen nt
    s_mov_b32 s68, s28
    s_and_b32 s69, s29, 0xffff
    s_mov_b32 s70, 0x1c0000
    s_mov_b32 s71, 0x20000
    s_mov_b32 s72, s30
    s_and_b32 s73, s31, 0xffff
    s_mov_b32 s74, 0x1c0000
    s_mov_b32 s75, 0x20000
    v_mul_u32_u24 v38, 57344, v35
    v_and_b32 v36, 0x70, v36
    v_add_u32 v38, v38, v36
    s_lshl_b32 s3, s91, 7
    s_cmp_lt_u32 s91, 28
    s_cselect_b32 s3, s3, 0x7f000000
    s_mov_b32 exec_lo, 0xff00ff
    s_mov_b32 exec_hi, 0xff00ff
    buffer_load_dwordx4 v[168:171], v38, s[68:71], s3 offen nt
    s_add_u32 s3, s3, 0xe00
    buffer_load_dwordx4 v[172:175], v38, s[68:71], s3 offen nt
    s_add_u32 s3, s3, 0xe00
    buffer_load_dwordx4 v[176:179], v38, s[68:71], s3 offen nt
    s_add_u32 s3, s3, 0xe00
    buffer_load_dwordx4 v[180:183], v38, s[68:71], s3 offen nt
    s_add_u32 s3, s3, 0xe00
    buffer_load_dwordx4 v[184:187], v38, s[68:71], s3 offen nt
    s_add_u32 s3, s3, 0xe00
    buffer_load_dwordx4 v[188:191], v38, s[68:71], s3 offen nt
    s_add_u32 s3, s3, 0xe00
    buffer_load_dwordx4 v[192:195], v38, s[68:71], s3 offen nt
    s_add_u32 s3, s3, 0xe00
    buffer_load_dwordx4 v[196:199], v38, s[68:71], s3 offen nt
    s_add_u32 s3, s3, 0xe00
    buffer_load_dwordx4 v[200:203], v38, s[68:71], s3 offen nt
    s_add_u32 s3, s3, 0xe00
    buffer_load_dwordx4 v[204:207], v38, s[68:71], s3 offen nt
    s_add_u32 s3, s3, 0xe00
    buffer_load_dwordx4 v[208:211], v38, s[68:71], s3 offen nt
    s_add_u32 s3, s3, 0xe00
    buffer_load_dwordx4 v[212:215], v38, s[68:71], s3 offen nt
    s_add_u32 s3, s3, 0xe00
    buffer_load_dwordx4 v[216:219], v38, s[68:71], s3 offen nt
    s_add_u32 s3, s3, 0xe00
    buffer_load_dwordx4 v[220:223], v38, s[68:71], s3 offen nt
    s_add_u32 s3, s3, 0xe00
    buffer_load_dwordx4 v[224:227], v38, s[68:71], s3 offen nt
    s_add_u32 s3, s3, 0xe00
    buffer_load_dwordx4 v[228:231], v38, s[68:71], s3 offen nt
    s_lshl_b32 s3, s91, 7
    s_cmp_lt_u32 s91, 28
    s_cselect_b32 s3, s3, 0x7f000000
    s_mov_b32 exec_lo, 0xff00ff00
    s_mov_b32 exec_hi, 0xff00ff00
    buffer_load_dwordx4 v[168:171], v38, s[72:75], s3 offen nt
    s_add_u32 s3, s3, 0xe00
    buffer_load_dwordx4 v[172:175], v38, s[72:75], s3 offen nt
    s_add_u32 s3, s3, 0xe00
    buffer_load_dwordx4 v[176:179], v38, s[72:75], s3 offen nt
    s_add_u32 s3, s3, 0xe00
    buffer_load_dwordx4 v[180:183], v38, s[72:75], s3 offen nt
    s_add_u32 s3, s3, 0xe00
    buffer_load_dwordx4 v[184:187], v38, s[72:75], s3 offen nt
    s_add_u32 s3, s3, 0xe00
    buffer_load_dwordx4 v[188:191], v38, s[72:75], s3 offen nt
    s_add_u32 s3, s3, 0xe00
    buffer_load_dwordx4 v[192:195], v38, s[72:75], s3 offen nt
    s_add_u32 s3, s3, 0xe00
    buffer_load_dwordx4 v[196:199], v38, s[72:75], s3 offen nt
    s_add_u32 s3, s3, 0xe00
    buffer_load_dwordx4 v[200:203], v38, s[72:75], s3 offen nt
    s_add_u32 s3, s3, 0xe00
    buffer_load_dwordx4 v[204:207], v38, s[72:75], s3 offen nt
    s_add_u32 s3, s3, 0xe00
    buffer_load_dwordx4 v[208:211], v38, s[72:75], s3 offen nt
    s_add_u32 s3, s3, 0xe00
    buffer_load_dwordx4 v[212:215], v38, s[72:75], s3 offen nt
    s_add_u32 s3, s3, 0xe00
    buffer_load_dwordx4 v[216:219], v38, s[72:75], s3 offen nt
    s_add_u32 s3, s3, 0xe00
    buffer_load_dwordx4 v[220:223], v38, s[72:75], s3 offen nt
    s_add_u32 s3, s3, 0xe00
    buffer_load_dwordx4 v[224:227], v38, s[72:75], s3 offen nt
    s_add_u32 s3, s3, 0xe00
    buffer_load_dwordx4 v[228:231], v38, s[72:75], s3 offen nt
    s_mov_b64 exec, -1
    s_mov_b32 s64, s32
    s_and_b32 s65, s33, 0xffff
    s_mov_b32 s66, 0x1c0000
    s_mov_b32 s67, 0x20000
    v_lshrrev_b32 v39, 1, v0
    v_lshlrev_b32 v39, 13, v39
    v_and_b32 v36, 1, v0
    v_lshl_add_u32 v39, v36, 4, v39
    s_lshl_b32 s3, s91, 5
    buffer_load_dwordx4 v[40:43], v39, s[64:67], s3 offen nt
    s_add_u32 s3, s3, 0x400
    buffer_load_dwordx4 v[44:47], v39, s[64:67], s3 offen nt
    s_add_u32 s3, s3, 0x400
    buffer_load_dwordx4 v[48:51], v39, s[64:67], s3 offen nt
    s_add_u32 s3, s3, 0x400
    buffer_load_dwordx4 v[52:55], v39, s[64:67], s3 offen nt
    s_add_u32 s3, s3, 0x400
    buffer_load_dwordx4 v[56:59], v39, s[64:67], s3 offen nt
    s_add_u32 s3, s3, 0x400
    buffer_load_dwordx4 v[60:63], v39, s[64:67], s3 offen nt
    s_add_u32 s3, s3, 0x400
    buffer_load_dwordx4 v[64:67], v39, s[64:67], s3 offen nt
    s_add_u32 s3, s3, 0x400
    buffer_load_dwordx4 v[68:71], v39, s[64:67], s3 offen nt
    s_lshl_b32 s3, s4, 1
    s_add_u32 s3, s3, s98
    s_lshl_b32 s76, s3, 12
    s_add_u32 s3, s76, 4096
    buffer_load_dwordx4 v[72:75], v1, s[8:11], s76 offen offset:0 nt
    buffer_load_dwordx4 v[76:79], v1, s[8:11], s76 offen offset:1024 nt
    buffer_load_dwordx4 v[80:83], v1, s[8:11], s76 offen offset:2048 nt
    buffer_load_dwordx4 v[84:87], v1, s[8:11], s76 offen offset:3072 nt
    buffer_load_dwordx4 v[88:91], v1, s[8:11], s3 offen offset:0 nt
    buffer_load_dwordx4 v[92:95], v1, s[8:11], s3 offen offset:1024 nt
    buffer_load_dwordx4 v[96:99], v1, s[8:11], s3 offen offset:2048 nt
    buffer_load_dwordx4 v[100:103], v1, s[8:11], s3 offen offset:3072 nt
    s_branch L_nobulk
L_N2:
    s_nop 4
    s_cmp_lg_u32 s4, 1
    s_cbranch_scc1 L_bulk
    v_mov_b32 v36, -1
    v_mov_b32 v37, -1
    v_mov_b32 v38, -1
    v_mov_b32 v39, -1
    v_mov_b32 v34, 0
    v_mov_b32 v35, 0
    s_lshl_b32 s3, s26, 9
    s_add_u32 s3, s3, 0x10000
    s_mov_b32 exec_hi, 0
    buffer_store_dwordx4 v[36:39], v1, s[44:47], s3 offen sc1
    s_lshl_b32 s3, s2, 8
    s_add_u32 s3, s3, 0x4000
    s_cmp_lt_u32 s2, 96
    s_cselect_b32 s3, s3, 0x7f000000
    s_mov_b64 exec, 0xffff
    buffer_store_dwordx4 v[36:39], v1, s[44:47], s3 offen sc1
    s_lshl_b32 s3, s26, 7
    s_add_u32 s3, s3, 0x38000
    s_mov_b64 exec, 1
    buffer_store_dwordx2 v[36:37], v34, s[44:47], s3 offen sc1
    s_cmp_eq_u32 s6, 0
    s_cselect_b32 s3, s93, 0x7f000000
    buffer_store_dwordx2 v[34:35], v34, s[44:47], s3 offen sc1
    s_mov_b64 exec, -1
L_bulk:
    s_nop 4
    s_cmp_eq_u32 s90, 0
    s_cbranch_scc1 L_fast
L_bulk2:
    s_nop 4
    s_lshl_b32 s3, s4, 1
    s_add_u32 s3, s3, s98
    s_lshl_b32 s76, s3, 12
    s_add_u32 s3, s76, 4096
    buffer_load_dwordx4 v[104:107], v1, s[8:11], s76 offen offset:0 nt
    buffer_load_dwordx4 v[108:111], v1, s[8:11], s76 offen offset:1024 nt
    buffer_load_dwordx4 v[112:115], v1, s[8:11], s76 offen offset:2048 nt
    buffer_load_dwordx4 v[116:119], v1, s[8:11], s76 offen offset:3072 nt
    buffer_load_dwordx4 v[120:123], v1, s[8:11], s3 offen offset:0 nt
    buffer_load_dwordx4 v[124:127], v1, s[8:11], s3 offen offset:1024 nt
    buffer_load_dwordx4 v[128:131], v1, s[8:11], s3 offen offset:2048 nt
    buffer_load_dwordx4 v[132:135], v1, s[8:11], s3 offen offset:3072 nt
    s_add_u32 s76, s76, 0x10000
    s_add_u32 s3, s76, 4096
    buffer_load_dwordx4 v[136:139], v1, s[8:11], s76 offen offset:0 nt
    buffer_load_dwordx4 v[140:143], v1, s[8:11], s76 offen offset:1024 nt
    buffer_load_dwordx4 v[144:147], v1, s[8:11], s76 offen offset:2048 nt
    buffer_load_dwordx4 v[148:151], v1, s[8:11], s76 offen offset:3072 nt
    buffer_load_dwordx4 v[152:155], v1, s[8:11], s3 offen offset:0 nt
    buffer_load_dwordx4 v[156:159], v1, s[8:11], s3 offen offset:1024 nt
    buffer_load_dwordx4 v[160:163], v1, s[8:11], s3 offen offset:2048 nt
    buffer_load_dwordx4 v[164:167], v1, s[8:11], s3 offen offset:3072 nt
    s_add_u32 s76, s76, 0x10000
    s_add_u32 s3, s76, 4096
    buffer_load_dwordx4 v[168:171], v1, s[8:11], s76 offen offset:0 nt
    buffer_load_dwordx4 v[172:175], v1, s[8:11], s76 offen offset:1024 nt
    buffer_load_dwordx4 v[176:179], v1, s[8:11], s76 offen offset:2048 nt
    buffer_load_dwordx4 v[180:183], v1, s[8:11], s76 offen offset:3072 nt
    buffer_load_dwordx4 v[184:187], v1, s[8:11], s3 offen offset:0 nt
    buffer_load_dwordx4 v[188:191], v1, s[8:11], s3 offen offset:1024 nt
    buffer_load_dwordx4 v[192:195], v1, s[8:11], s3 offen offset:2048 nt
    buffer_load_dwordx4 v[196:199], v1, s[8:11], s3 offen offset:3072 nt
    s_add_u32 s76, s76, 0x10000
    s_add_u32 s3, s76, 4096
    buffer_load_dwordx4 v[200:203], v1, s[8:11], s76 offen offset:0 nt
    buffer_load_dwordx4 v[204:207], v1, s[8:11], s76 offen offset:1024 nt
    buffer_load_dwordx4 v[208:211], v1, s[8:11], s76 offen offset:2048 nt
    buffer_load_dwordx4 v[212:215], v1, s[8:11], s76 offen offset:3072 nt
    buffer_load_dwordx4 v[216:219], v1, s[8:11], s3 offen offset:0 nt
    buffer_load_dwordx4 v[220:223], v1, s[8:11], s3 offen offset:1024 nt
    buffer_load_dwordx4 v[224:227], v1, s[8:11], s3 offen offset:2048 nt
    buffer_load_dwordx4 v[228:231], v1, s[8:11], s3 offen offset:3072 nt
    s_add_u32 s76, s76, 0x10000
    s_add_u32 s3, s76, 4096
    buffer_load_dwordx4 v[72:75], v1, s[8:11], s76 offen offset:0 nt
    buffer_load_dwordx4 v[76:79], v1, s[8:11], s76 offen offset:1024 nt
    buffer_load_dwordx4 v[80:83], v1, s[8:11], s76 offen offset:2048 nt
    buffer_load_dwordx4 v[84:87], v1, s[8:11], s76 offen offset:3072 nt
    buffer_load_dwordx4 v[88:91], v1, s[8:11], s3 offen offset:0 nt
    buffer_load_dwordx4 v[92:95], v1, s[8:11], s3 offen offset:1024 nt
    buffer_load_dwordx4 v[96:99], v1, s[8:11], s3 offen offset:2048 nt
    buffer_load_dwordx4 v[100:103], v1, s[8:11], s3 offen offset:3072 nt
L_nobulk:
    s_nop 4
    s_waitcnt lgkmcnt(0)
    s_mul_i32 s100, s100, 0x41c64e6d
    s_add_u32 s100, s100, 0x3039
    s_cmp_lg_u32 s90, 2
    s_cbranch_scc1 L_notM2
    s_waitcnt vmcnt(40)
    v_lshlrev_b32 v32, 16, v32
    v_mul_f32 v34, s88, v32
    v_exp_f32 v34, -v34
    s_nop 0
    v_min_f32 v34, 0x7f000000, v34
    v_add_f32 v34, 1.0, v34
    v_rcp_f32 v35, v34
    s_nop 0
    v_mul_f32 v33, v32, v35
    v_fma_f32 v36, -v33, v34, v32
    v_fmac_f32 v33, v36, v35
    v_cvt_pk_bf16_f32 v34, 0, v33
    v_lshlrev_b32 v35, 2, v0
    ds_write_b32 v35, v34 offset:2048
    s_waitcnt lgkmcnt(0)
    v_lshrrev_b32 v8, 3, v0
    v_lshlrev_b32 v8, 5, v8
    ds_read_b128 v[16:19], v8 offset:2048
    ds_read_b128 v[20:23], v8 offset:2064
    v_and_b32 v9, 7, v0
    v_lshlrev_b32 v9, 5, v9
    v_bfe_u32 v10, v0, 4, 2
    v_lshl_add_u32 v9, v10, 3, v9
    v_lshrrev_b32 v10, 6, v0
    v_lshl_add_u32 v9, v10, 8, v9
    s_waitcnt lgkmcnt(0)
    v_lshrrev_b32 v12, 16, v16
    v_lshrrev_b32 v13, 16, v17
    v_lshrrev_b32 v14, 16, v18
    v_lshrrev_b32 v15, 16, v19
    v_dot2_f32_bf16 v24, v40, v12, 0
    v_dot2_f32_bf16 v25, v40, v16, 0
    v_dot2_f32_bf16 v26, v41, v12, 0
    v_dot2_f32_bf16 v27, v41, v16, 0
    v_dot2_f32_bf16 v28, v42, v12, 0
    v_dot2_f32_bf16 v29, v42, v16, 0
    v_dot2_f32_bf16 v30, v43, v12, 0
    v_dot2_f32_bf16 v31, v43, v16, 0
    v_lshrrev_b32 v12, 16, v20
    v_dot2_f32_bf16 v24, v44, v13, v24
    v_dot2_f32_bf16 v25, v44, v17, v25
    v_dot2_f32_bf16 v26, v45, v13, v26
    v_dot2_f32_bf16 v27, v45, v17, v27
    v_dot2_f32_bf16 v28, v46, v13, v28
    v_dot2_f32_bf16 v29, v46, v17, v29
    v_dot2_f32_bf16 v30, v47, v13, v30
    v_dot2_f32_bf16 v31, v47, v17, v31
    v_lshrrev_b32 v13, 16, v21
    v_dot2_f32_bf16 v24, v48, v14, v24
    v_dot2_f32_bf16 v25, v48, v18, v25
    v_dot2_f32_bf16 v26, v49, v14, v26
    v_dot2_f32_bf16 v27, v49, v18, v27
    v_dot2_f32_bf16 v28, v50, v14, v28
    v_dot2_f32_bf16 v29, v50, v18, v29
    v_dot2_f32_bf16 v30, v51, v14, v30
    v_dot2_f32_bf16 v31, v51, v18, v31
    v_lshrrev_b32 v14, 16, v22
    v_dot2_f32_bf16 v24, v52, v15, v24
    v_dot2_f32_bf16 v25, v52, v19, v25
    v_dot2_f32_bf16 v26, v53, v15, v26
    v_dot2_f32_bf16 v27, v53, v19, v27
    v_dot2_f32_bf16 v28, v54, v15, v28
    v_dot2_f32_bf16 v29, v54, v19, v29
    v_dot2_f32_bf16 v30, v55, v15, v30
    v_dot2_f32_bf16 v31, v55, v19, v31
    v_lshrrev_b32 v15, 16, v23
    v_dot2_f32_bf16 v24, v56, v12, v24
    v_dot2_f32_bf16 v25, v56, v20, v25
    v_dot2_f32_bf16 v26, v57, v12, v26
    v_dot2_f32_bf16 v27, v57, v20, v27
    v_dot2_f32_bf16 v28, v58, v12, v28
    v_dot2_f32_bf16 v29, v58, v20, v29
    v_dot2_f32_bf16 v30, v59, v12, v30
    v_dot2_f32_bf16 v31, v59, v20, v31
    v_dot2_f32_bf16 v24, v60, v13, v24
    v_dot2_f32_bf16 v25, v60, v21, v25
    v_dot2_f32_bf16 v26, v61, v13, v26
    v_dot2_f32_bf16 v27, v61, v21, v27
    v_dot2_f32_bf16 v28, v62, v13, v28
    v_dot2_f32_bf16 v29, v62, v21, v29
    v_dot2_f32_bf16 v30, v63, v13, v30
    v_dot2_f32_bf16 v31, v63, v21, v31
    v_dot2_f32_bf16 v24, v64, v14, v24
    v_dot2_f32_bf16 v25, v64, v22, v25
    v_dot2_f32_bf16 v26, v65, v14, v26
    v_dot2_f32_bf16 v27, v65, v22, v27
    v_dot2_f32_bf16 v28, v66, v14, v28
    v_dot2_f32_bf16 v29, v66, v22, v29
    v_dot2_f32_bf16 v30, v67, v14, v30
    v_dot2_f32_bf16 v31, v67, v22, v31
    v_dot2_f32_bf16 v24, v68, v15, v24
    v_dot2_f32_bf16 v25, v68, v23, v25
    v_dot2_f32_bf16 v26, v69, v15, v26
    v_dot2_f32_bf16 v27, v69, v23, v27
    v_dot2_f32_bf16 v28, v70, v15, v28
    v_dot2_f32_bf16 v29, v70, v23, v29
    v_dot2_f32_bf16 v30, v71, v15, v30
    v_dot2_f32_bf16 v31, v71, v23, v31
    v_permlane32_swap_b32 v24, v28
    v_permlane32_swap_b32 v25, v29
    v_permlane32_swap_b32 v26, v30
    v_permlane32_swap_b32 v27, v31
    v_add_f32 v24, v24, v28
    v_add_f32 v25, v25, v29
    v_add_f32 v26, v26, v30
    v_add_f32 v27, v27, v31
    s_nop 0
    v_permlane16_swap_b32 v24, v26
    v_permlane16_swap_b32 v25, v27
    v_add_f32 v24, v24, v26
    v_add_f32 v25, v25, v27
    s_nop 0
    v_add_f32_dpp v24, v24, v24 row_ror:8 row_mask:0xf bank_mask:0xf
    v_add_f32_dpp v25, v25, v25 row_ror:8 row_mask:0xf bank_mask:0xf
    ds_write_b64 v9, v[24:25] offset:6144
L_notM2:
    s_nop 4
    s_cmp_lg_u32 s4, 0
    s_cbranch_scc1 L_waitq
    s_lshl_b32 s96, s90, 2
    s_lshr_b32 s96, 0x445, s96
    s_and_b32 s96, s96, 15
    s_lshl_b32 s3, s96, 3
    s_add_u32 s3, s3, 8
    v_mov_b32 v35, 0
    v_mov_b32 v36, s3
    v_mov_b32 v37, 0
    ds_write_b64 v35, v[36:37] offset:0
    v_lshlrev_b32 v35, 3, v2
    s_lshl_b32 s3, s5, 9
    s_add_u32 s3, s3, 0xc000
L_pq:
    s_nop 4
    buffer_load_dwordx2 v[24:25], v35, s[44:47], s3 offen sc1
    s_waitcnt vmcnt(0)
    v_xor_b32 v36, s100, v25
    v_mov_b32 v26, v24
    v_cmp_ne_u32 vcc, 0, v36
    s_cbranch_vccz L_pq_ok
    s_add_u32 s94, s94, 1
    s_cmp_lt_u32 s94, 0x40000
    s_cbranch_scc1 L_pq
    s_branch L_end
L_pq_ok:
    s_nop 4
    v_lshlrev_b32 v35, 2, v2
    ds_write_b32 v35, v26 offset:256
L_waitq:
    s_nop 4
    s_lshl_b32 s96, s90, 2
    s_lshr_b32 s96, 0x445, s96
    s_and_b32 s96, s96, 15
    s_cmp_lt_u32 s2, 64
    s_cselect_b32 s83, 14, 15
    v_lshl_add_u32 v35, v0, 4, s98
    v_lshl_add_u32 v35, v0, 20, v35
    v_or_b32 v36, 0x80000000, v35
    v_cmp_eq_u32 vcc, s83, v0
    s_nop 1
    v_cndmask_b32 v35, v35, v36, vcc
    v_mov_b32 v36, -1
    v_cmp_lt_u32 vcc, s83, v0
    s_nop 1
    v_cndmask_b32 v35, v35, v36, vcc
    v_lshlrev_b32 v37, 2, v0
    ds_write_b32 v37, v35 offset:16384
    v_and_b32 v37, 0x1fc, v37
    ds_write_b32 v37, v36 offset:18432
    s_waitcnt lgkmcnt(0)
    s_barrier
    v_and_b32 v35, 15, v0
    v_lshlrev_b32 v35, 4, v35
    ds_read_b128 v[4:7], v35 offset:256
    v_mov_b32 v18, 0
    v_mov_b32 v19, 1
    v_lshlrev_b32 v232, 1, v35
    v_bfe_u32 v36, v0, 4, 2
    v_lshl_add_u32 v232, v36, 3, v232
    v_lshrrev_b32 v233, 6, v0
    v_lshl_add_u32 v232, v233, 9, v232
    v_lshlrev_b32 v233, 3, v233
    s_mov_b32 s101, 0
    s_mov_b32 s80, 0
    v_lshlrev_b32 v239, 4, v36
    v_add_u32 v239, 0x5000, v239
    s_lshl_b32 s3, s96, 3
    s_add_u32 s3, s3, s4
    s_lshl_b32 s3, s3, 6
    v_add_u32 v236, s3, v239
    s_mov_b64 s[64:65], s[8:9]
    s_mov_b32 s66, 0x1000000
    s_mov_b32 s67, 0x20000
    s_mov_b64 s[68:69], s[8:9]
    s_mov_b32 s70, 0x1000000
    s_mov_b32 s71, 0x20000
    v_mov_b32 v8, 0
    v_mov_b32 v9, 0
    v_mov_b32 v10, 0
    v_mov_b32 v11, 0
    v_mov_b32 v12, 0
    v_mov_b32 v13, 0
    v_mov_b32 v14, 0
    v_mov_b32 v15, 0
    v_mov_b32 v16, 0xff61b1e6
    v_mov_b32 v17, 0
    s_mov_b32 s95, 0x7fffffff
    s_mov_b32 s92, 1
    s_waitcnt lgkmcnt(0)
    s_cmp_eq_u32 s4, 0
    s_cbranch_scc1 L_ctl
    s_cmp_lg_u32 s4, 1
    s_cbranch_scc1 L_loop
    s_add_u32 s3, s1, 1
    v_mov_b32 v237, s3
    s_waitcnt vmcnt(40)
    s_mov_b64 exec, 1
    buffer_atomic_add v237, off, s[48:51], 0
    s_mov_b64 exec, -1
    s_branch L_loop
L_ctl:
    s_nop 4
    s_mov_b32 s95, 4
    s_cmp_lg_u32 s90, 2
    s_cbranch_scc1 L_ctl2
    v_and_b32 v25, 63, v2
    v_lshlrev_b32 v25, 2, v25
    ds_read_b32 v28, v25 offset:6144
    ds_read_b32 v29, v25 offset:6400
    ds_read_b32 v30, v25 offset:6656
    ds_read_b32 v31, v25 offset:6912
    ds_read_b32 v32, v25 offset:7168
    ds_read_b32 v33, v25 offset:7424
    ds_read_b32 v34, v25 offset:7680
    ds_read_b32 v35, v25 offset:7936
    s_waitcnt lgkmcnt(0)
    v_add_f32 v28, v28, v32
    v_add_f32 v29, v29, v33
    v_add_f32 v30, v30, v34
    v_add_f32 v31, v31, v35
    v_add_f32 v28, v28, v30
    v_add_f32 v29, v29, v31
    v_add_f32 v24, v28, v29
    v_cvt_pk_bf16_f32 v24, 0, v24
    s_lshl_b32 s3, s91, 8
    s_add_u32 s3, s3, 0x1000
    v_mov_b32 v28, v24
    s_nop 1
    v_mov_b32_dpp v29, v28 quad_perm:[1,1,1,1] row_mask:0xf bank_mask:0xf
    v_mov_b32_dpp v30, v28 quad_perm:[2,2,2,2] row_mask:0xf bank_mask:0xf
    v_mov_b32_dpp v31, v28 quad_perm:[3,3,3,3] row_mask:0xf bank_mask:0xf
    s_mov_b32 exec_lo, 0x11111111
    s_mov_b32 exec_hi, 0x11111111
    buffer_store_dwordx4 v[28:31], v25, s[44:47], s3 offen sc1
    s_mov_b64 exec, -1
    s_nop 1
L_ctl2:
    s_nop 4
    s_cmp_lg_u32 s90, 1
    s_cbranch_scc1 L_ctl3
    s_lshl_b32 s3, s4, 1
    s_add_u32 s3, s3, s98
    s_lshl_b32 s76, s3, 12
    s_add_u32 s3, s76, 4096
    buffer_load_dwordx4 v[104:107], v1, s[8:11], s76 offen offset:0 nt
    buffer_load_dwordx4 v[108:111], v1, s[8:11], s76 offen offset:1024 nt
    buffer_load_dwordx4 v[112:115], v1, s[8:11], s76 offen offset:2048 nt
    buffer_load_dwordx4 v[116:119], v1, s[8:11], s76 offen offset:3072 nt
    buffer_load_dwordx4 v[120:123], v1, s[8:11], s3 offen offset:0 nt
    buffer_load_dwordx4 v[124:127], v1, s[8:11], s3 offen offset:1024 nt
    buffer_load_dwordx4 v[128:131], v1, s[8:11], s3 offen offset:2048 nt
    buffer_load_dwordx4 v[132:135], v1, s[8:11], s3 offen offset:3072 nt
    s_add_u32 s76, s76, 0x10000
    s_add_u32 s3, s76, 4096
    buffer_load_dwordx4 v[136:139], v1, s[8:11], s76 offen offset:0 nt
    buffer_load_dwordx4 v[140:143], v1, s[8:11], s76 offen offset:1024 nt
    buffer_load_dwordx4 v[144:147], v1, s[8:11], s76 offen offset:2048 nt
    buffer_load_dwordx4 v[148:151], v1, s[8:11], s76 offen offset:3072 nt
    buffer_load_dwordx4 v[152:155], v1, s[8:11], s3 offen offset:0 nt
    buffer_load_dwordx4 v[156:159], v1, s[8:11], s3 offen offset:1024 nt
    buffer_load_dwordx4 v[160:163], v1, s[8:11], s3 offen offset:2048 nt
    buffer_load_dwordx4 v[164:167], v1, s[8:11], s3 offen offset:3072 nt
    s_add_u32 s76, s76, 0x10000
    s_add_u32 s3, s76, 4096
    buffer_load_dwordx4 v[168:171], v1, s[8:11], s76 offen offset:0 nt
    buffer_load_dwordx4 v[172:175], v1, s[8:11], s76 offen offset:1024 nt
    buffer_load_dwordx4 v[176:179], v1, s[8:11], s76 offen offset:2048 nt
    buffer_load_dwordx4 v[180:183], v1, s[8:11], s76 offen offset:3072 nt
    buffer_load_dwordx4 v[184:187], v1, s[8:11], s3 offen offset:0 nt
    buffer_load_dwordx4 v[188:191], v1, s[8:11], s3 offen offset:1024 nt
    buffer_load_dwordx4 v[192:195], v1, s[8:11], s3 offen offset:2048 nt
    buffer_load_dwordx4 v[196:199], v1, s[8:11], s3 offen offset:3072 nt
    s_add_u32 s76, s76, 0x10000
    s_add_u32 s3, s76, 4096
    buffer_load_dwordx4 v[200:203], v1, s[8:11], s76 offen offset:0 nt
    buffer_load_dwordx4 v[204:207], v1, s[8:11], s76 offen offset:1024 nt
    buffer_load_dwordx4 v[208:211], v1, s[8:11], s76 offen offset:2048 nt
    buffer_load_dwordx4 v[212:215], v1, s[8:11], s76 offen offset:3072 nt
    buffer_load_dwordx4 v[216:219], v1, s[8:11], s3 offen offset:0 nt
    buffer_load_dwordx4 v[220:223], v1, s[8:11], s3 offen offset:1024 nt
    buffer_load_dwordx4 v[224:227], v1, s[8:11], s3 offen offset:2048 nt
    buffer_load_dwordx4 v[228:231], v1, s[8:11], s3 offen offset:3072 nt
    s_add_u32 s76, s76, 0x10000
    s_add_u32 s3, s76, 4096
    buffer_load_dwordx4 v[72:75], v1, s[8:11], s76 offen offset:0 nt
    buffer_load_dwordx4 v[76:79], v1, s[8:11], s76 offen offset:1024 nt
    buffer_load_dwordx4 v[80:83], v1, s[8:11], s76 offen offset:2048 nt
    buffer_load_dwordx4 v[84:87], v1, s[8:11], s76 offen offset:3072 nt
    buffer_load_dwordx4 v[88:91], v1, s[8:11], s3 offen offset:0 nt
    buffer_load_dwordx4 v[92:95], v1, s[8:11], s3 offen offset:1024 nt
    buffer_load_dwordx4 v[96:99], v1, s[8:11], s3 offen offset:2048 nt
    buffer_load_dwordx4 v[100:103], v1, s[8:11], s3 offen offset:3072 nt
L_ctl3:
    s_nop 4
    s_setprio 0
.p2align 6
L_loop:
    s_sub_u32 s92, s92, 1
    s_cbranch_scc1 L_hook
L_loop2:
    s_cmp_lg_u32 s80, 0
    s_cbranch_scc1 L_notK
    s_waitcnt vmcnt(4)
    s_mov_b64 exec, 1
    ds_add_rtn_u32 v20, v18, v19
    s_mov_b64 exec, -1
    v_dot2_f32_bf16 v32, v72, v4, 0
    v_dot2_f32_bf16 v33, v76, v4, 0
    v_dot2_f32_bf16 v34, v80, v4, 0
    v_dot2_f32_bf16 v35, v84, v4, 0
    v_dot2_f32_bf16 v32, v73, v5, v32
    v_dot2_f32_bf16 v33, v77, v5, v33
    v_dot2_f32_bf16 v34, v81, v5, v34
    v_dot2_f32_bf16 v35, v85, v5, v35
    v_dot2_f32_bf16 v32, v74, v6, v32
    v_dot2_f32_bf16 v33, v78, v6, v33
    v_dot2_f32_bf16 v34, v82, v6, v34
    v_dot2_f32_bf16 v35, v86, v6, v35
    v_dot2_f32_bf16 v32, v75, v7, v32
    v_dot2_f32_bf16 v33, v79, v7, v33
    v_dot2_f32_bf16 v34, v83, v7, v34
    v_dot2_f32_bf16 v35, v87, v7, v35
    s_waitcnt lgkmcnt(0)
    v_readfirstlane_b32 s82, v20
    s_lshr_b32 s3, s82, 3
    s_lshl_b32 s3, s3, 2
    v_mov_b32 v23, s3
    ds_read_b32 v20, v23 offset:16384
    v_add_f32_dpp v32, v32, v32 row_ror:8 row_mask:0xf bank_mask:0xf
    v_add_f32_dpp v33, v33, v33 row_ror:8 row_mask:0xf bank_mask:0xf
    v_add_f32_dpp v34, v34, v34 row_ror:8 row_mask:0xf bank_mask:0xf
    v_add_f32_dpp v35, v35, v35 row_ror:8 row_mask:0xf bank_mask:0xf
    v_add_f32_dpp v32, v32, v32 row_ror:4 row_mask:0xf bank_mask:0xf
    v_add_f32_dpp v33, v33, v33 row_ror:4 row_mask:0xf bank_mask:0xf
    v_add_f32_dpp v34, v34, v34 row_ror:4 row_mask:0xf bank_mask:0xf
    v_add_f32_dpp v35, v35, v35 row_ror:4 row_mask:0xf bank_mask:0xf
    v_add_f32_dpp v32, v32, v32 row_ror:2 row_mask:0xf bank_mask:0xf
    v_add_f32_dpp v33, v33, v33 row_ror:2 row_mask:0xf bank_mask:0xf
    v_add_f32_dpp v34, v34, v34 row_ror:2 row_mask:0xf bank_mask:0xf
    v_add_f32_dpp v35, v35, v35 row_ror:2 row_mask:0xf bank_mask:0xf
    v_add_f32_dpp v32, v32, v32 row_ror:1 row_mask:0xf bank_mask:0xf
    v_add_f32_dpp v33, v33, v33 row_ror:1 row_mask:0xf bank_mask:0xf
    v_add_f32_dpp v34, v34, v34 row_ror:1 row_mask:0xf bank_mask:0xf
    v_add_f32_dpp v35, v35, v35 row_ror:1 row_mask:0xf bank_mask:0xf
    v_cvt_pk_bf16_f32 v32, 0, v32
    v_cvt_pk_bf16_f32 v33, 0, v33
    v_cvt_pk_bf16_f32 v34, 0, v34
    v_cvt_pk_bf16_f32 v35, 0, v35
    v_mul_f32 v32, s89, v32
    v_mul_f32 v33, s89, v33
    v_mul_f32 v34, s89, v34
    v_mul_f32 v35, s89, v35
    v_max3_f32 v16, v16, v32, v33
    v_max3_f32 v16, v16, v34, v35
    s_waitcnt lgkmcnt(0)
    v_readfirstlane_b32 s3, v20
    s_and_b32 s7, s82, 7
    s_cmp_lt_i32 s3, 0
    s_cbranch_scc1 L_dyn
L_dynretK:
    s_lshr_b32 s78, s3, 29
    s_bfe_u32 s79, s3, 0x90014
    s_and_b32 s3, s3, 0x1fff
    s_lshl3_add_u32 s79, s79, s7
    s_lshl_b32 s79, s79, 6
    s_add_u32 s3, s3, s7
    s_cmp_eq_u32 s78, 2
    s_cselect_b32 s7, 0, s7
    s_cselect_b32 s77, 0, 4096
    s_add_u32 s3, s3, s7
    s_lshl_b32 s7, s3, 12
    s_cmp_lt_u32 s3, 4096
    s_cselect_b32 s76, s7, 0x7f000000
    s_add_u32 s77, s77, s76
    s_cmp_eq_u32 s78, 1
    s_cselect_b64 s[64:65], s[12:13], s[8:9]
    s_cmp_eq_u32 s78, 0
    s_cselect_b64 s[68:69], s[8:9], s[12:13]
    buffer_load_dwordx4 v[72:75], v1, s[64:67], s76 offen offset:0 nt
    buffer_load_dwordx4 v[76:79], v1, s[64:67], s76 offen offset:1024 nt
    buffer_load_dwordx4 v[80:83], v1, s[64:67], s76 offen offset:2048 nt
    buffer_load_dwordx4 v[84:87], v1, s[64:67], s76 offen offset:3072 nt
    s_waitcnt vmcnt(4)
    v_dot2_f32_bf16 v36, v88, v4, 0
    v_dot2_f32_bf16 v37, v92, v4, 0
    v_dot2_f32_bf16 v38, v96, v4, 0
    v_dot2_f32_bf16 v39, v100, v4, 0
    v_dot2_f32_bf16 v36, v89, v5, v36
    v_dot2_f32_bf16 v37, v93, v5, v37
    v_dot2_f32_bf16 v38, v97, v5, v38
    v_dot2_f32_bf16 v39, v101, v5, v39
    v_dot2_f32_bf16 v36, v90, v6, v36
    v_dot2_f32_bf16 v37, v94, v6, v37
    v_dot2_f32_bf16 v38, v98, v6, v38
    v_dot2_f32_bf16 v39, v102, v6, v39
    v_dot2_f32_bf16 v36, v91, v7, v36
    v_dot2_f32_bf16 v37, v95, v7, v37
    v_dot2_f32_bf16 v38, v99, v7, v38
    v_dot2_f32_bf16 v39, v103, v7, v39
    buffer_load_dwordx4 v[88:91], v1, s[68:71], s77 offen offset:0 nt
    buffer_load_dwordx4 v[92:95], v1, s[68:71], s77 offen offset:1024 nt
    buffer_load_dwordx4 v[96:99], v1, s[68:71], s77 offen offset:2048 nt
    buffer_load_dwordx4 v[100:103], v1, s[68:71], s77 offen offset:3072 nt
    v_add_f32_dpp v36, v36, v36 row_ror:8 row_mask:0xf bank_mask:0xf
    v_add_f32_dpp v37, v37, v37 row_ror:8 row_mask:0xf bank_mask:0xf
    v_add_f32_dpp v38, v38, v38 row_ror:8 row_mask:0xf bank_mask:0xf
    v_add_f32_dpp v39, v39, v39 row_ror:8 row_mask:0xf bank_mask:0xf
    v_add_f32_dpp v36, v36, v36 row_ror:4 row_mask:0xf bank_mask:0xf
    v_add_f32_dpp v37, v37, v37 row_ror:4 row_mask:0xf bank_mask:0xf
    v_add_f32_dpp v38, v38, v38 row_ror:4 row_mask:0xf bank_mask:0xf
    v_add_f32_dpp v39, v39, v39 row_ror:4 row_mask:0xf bank_mask:0xf
    v_add_f32_dpp v36, v36, v36 row_ror:2 row_mask:0xf bank_mask:0xf
    v_add_f32_dpp v37, v37, v37 row_ror:2 row_mask:0xf bank_mask:0xf
    v_add_f32_dpp v38, v38, v38 row_ror:2 row_mask:0xf bank_mask:0xf
    v_add_f32_dpp v39, v39, v39 row_ror:2 row_mask:0xf bank_mask:0xf
    v_add_f32_dpp v36, v36, v36 row_ror:1 row_mask:0xf bank_mask:0xf
    v_add_f32_dpp v37, v37, v37 row_ror:1 row_mask:0xf bank_mask:0xf
    v_add_f32_dpp v38, v38, v38 row_ror:1 row_mask:0xf bank_mask:0xf
    v_add_f32_dpp v39, v39, v39 row_ror:1 row_mask:0xf bank_mask:0xf
    v_cvt_pk_bf16_f32 v36, 0, v36
    v_cvt_pk_bf16_f32 v37, 0, v37
    v_cvt_pk_bf16_f32 v38, 0, v38
    v_cvt_pk_bf16_f32 v39, 0, v39
    v_mul_f32 v36, s89, v36
    v_mul_f32 v37, s89, v37
    v_mul_f32 v38, s89, v38
    v_mul_f32 v39, s89, v39
    v_max3_f32 v16, v16, v36, v37
    v_max3_f32 v16, v16, v38, v39
    v_cvt_pk_bf16_f32 v28, v32, v33
    v_cvt_pk_bf16_f32 v29, v34, v35
    v_cvt_pk_bf16_f32 v30, v36, v37
    v_cvt_pk_bf16_f32 v31, v38, v39
    ds_write_b128 v236, v[28:31]
    s_mov_b32 s80, s78
    v_add_u32 v236, s79, v239
    s_branch L_loop
L_sync:
    v_cvt_pk_bf16_f32 v16, 0, v16
    v_lshrrev_b32 v23, 4, v0
    v_lshlrev_b32 v23, 2, v23
    ds_write_b32 v23, v16 offset:128
    v_and_b32 v23, 31, v0
    v_lshlrev_b32 v23, 2, v23
    s_waitcnt lgkmcnt(0)
    s_barrier
    ds_read_b32 v16, v23 offset:128
    s_bitset1_b32 s27, 1
    s_waitcnt lgkmcnt(0)
    v_max_f32_dpp v16, v16, v16 row_ror:8 row_mask:0xf bank_mask:0xf
    s_nop 1
    v_max_f32_dpp v16, v16, v16 row_ror:4 row_mask:0xf bank_mask:0xf
    s_nop 1
    v_max_f32_dpp v16, v16, v16 row_ror:2 row_mask:0xf bank_mask:0xf
    s_nop 1
    v_max_f32_dpp v16, v16, v16 row_ror:1 row_mask:0xf bank_mask:0xf
    v_mov_b32 v23, v16
    s_nop 1
    v_permlane16_swap_b32 v16, v23
    v_max_f32 v16, v16, v23
    v_mov_b32 v23, v16
    s_nop 1
    v_permlane32_swap_b32 v16, v23
    v_max_f32 v16, v16, v23
    v_mul_f32 v21, s88, v16
L_notK:
    s_bitcmp0_b32 s27, 1
    s_cbranch_scc1 L_sync
    s_cmp_lg_u32 s80, 1
    s_cbranch_scc1 L_bodyF
    ds_read_b128 v[24:27], v236
    s_waitcnt lgkmcnt(0)
    v_lshlrev_b32 v28, 16, v24
    v_and_b32 v29, 0xffff0000, v24
    v_lshlrev_b32 v30, 16, v25
    v_and_b32 v31, 0xffff0000, v25
    v_fma_f32 v28, v28, s88, -v21
    v_fma_f32 v29, v29, s88, -v21
    v_fma_f32 v30, v30, s88, -v21
    v_fma_f32 v31, v31, s88, -v21
    v_exp_f32 v28, v28
    v_exp_f32 v29, v29
    v_exp_f32 v30, v30
    v_exp_f32 v31, v31
    v_cvt_pk_bf16_f32 v32, v28, 0
    v_cvt_pk_bf16_f32 v36, 0, v28
    v_cvt_pk_bf16_f32 v33, v29, 0
    v_cvt_pk_bf16_f32 v37, 0, v29
    v_cvt_pk_bf16_f32 v34, v30, 0
    v_cvt_pk_bf16_f32 v38, 0, v30
    v_cvt_pk_bf16_f32 v35, v31, 0
    v_cvt_pk_bf16_f32 v39, 0, v31
    v_add_f32 v17, v17, v28
    v_add_f32 v17, v17, v29
    v_add_f32 v17, v17, v30
    v_add_f32 v17, v17, v31
    s_waitcnt vmcnt(4)
    s_mov_b64 exec, 1
    ds_add_rtn_u32 v20, v18, v19
    s_mov_b64 exec, -1
    v_dot2_f32_bf16 v8, v72, v32, v8
    v_dot2_f32_bf16 v9, v72, v36, v9
    v_dot2_f32_bf16 v10, v73, v32, v10
    v_dot2_f32_bf16 v11, v73, v36, v11
    v_dot2_f32_bf16 v12, v74, v32, v12
    v_dot2_f32_bf16 v13, v74, v36, v13
    v_dot2_f32_bf16 v14, v75, v32, v14
    v_dot2_f32_bf16 v15, v75, v36, v15
    v_dot2_f32_bf16 v8, v76, v33, v8
    v_dot2_f32_bf16 v9, v76, v37, v9
    v_dot2_f32_bf16 v10, v77, v33, v10
    v_dot2_f32_bf16 v11, v77, v37, v11
    v_dot2_f32_bf16 v12, v78, v33, v12
    v_dot2_f32_bf16 v13, v78, v37, v13
    v_dot2_f32_bf16 v14, v79, v33, v14
    v_dot2_f32_bf16 v15, v79, v37, v15
    s_waitcnt lgkmcnt(0)
    v_readfirstlane_b32 s82, v20
    s_lshr_b32 s3, s82, 3
    s_lshl_b32 s3, s3, 2
    v_mov_b32 v23, s3
    ds_read_b32 v20, v23 offset:16384
    v_dot2_f32_bf16 v8, v80, v34, v8
    v_dot2_f32_bf16 v9, v80, v38, v9
    v_dot2_f32_bf16 v10, v81, v34, v10
    v_dot2_f32_bf16 v11, v81, v38, v11
    v_dot2_f32_bf16 v12, v82, v34, v12
    v_dot2_f32_bf16 v13, v82, v38, v13
    v_dot2_f32_bf16 v14, v83, v34, v14
    v_dot2_f32_bf16 v15, v83, v38, v15
    v_dot2_f32_bf16 v8, v84, v35, v8
    v_dot2_f32_bf16 v9, v84, v39, v9
    v_dot2_f32_bf16 v10, v85, v35, v10
    v_dot2_f32_bf16 v11, v85, v39, v11
    v_dot2_f32_bf16 v12, v86, v35, v12
    v_dot2_f32_bf16 v13, v86, v39, v13
    v_dot2_f32_bf16 v14, v87, v35, v14
    v_dot2_f32_bf16 v15, v87, v39, v15
    s_waitcnt lgkmcnt(0)
    v_readfirstlane_b32 s3, v20
    s_and_b32 s7, s82, 7
    s_cmp_lt_i32 s3, 0
    s_cbranch_scc1 L_dyn
L_dynretV:
    s_lshr_b32 s78, s3, 29
    s_bfe_u32 s79, s3, 0x90014
    s_and_b32 s3, s3, 0x1fff
    s_lshl3_add_u32 s79, s79, s7
    s_lshl_b32 s79, s79, 6
    s_add_u32 s3, s3, s7
    s_cmp_eq_u32 s78, 2
    s_cselect_b32 s7, 0, s7
    s_cselect_b32 s77, 0, 4096
    s_add_u32 s3, s3, s7
    s_lshl_b32 s7, s3, 12
    s_cmp_lt_u32 s3, 4096
    s_cselect_b32 s76, s7, 0x7f000000
    s_add_u32 s77, s77, s76
    s_cmp_eq_u32 s78, 1
    s_cselect_b64 s[64:65], s[12:13], s[8:9]
    s_cmp_eq_u32 s78, 0
    s_cselect_b64 s[68:69], s[8:9], s[12:13]
    buffer_load_dwordx4 v[72:75], v1, s[64:67], s76 offen offset:0 nt
    buffer_load_dwordx4 v[76:79], v1, s[64:67], s76 offen offset:1024 nt
    buffer_load_dwordx4 v[80:83], v1, s[64:67], s76 offen offset:2048 nt
    buffer_load_dwordx4 v[84:87], v1, s[64:67], s76 offen offset:3072 nt
    v_lshlrev_b32 v28, 16, v26
    v_and_b32 v29, 0xffff0000, v26
    v_lshlrev_b32 v30, 16, v27
    v_and_b32 v31, 0xffff0000, v27
    v_fma_f32 v28, v28, s88, -v21
    v_fma_f32 v29, v29, s88, -v21
    v_fma_f32 v30, v30, s88, -v21
    v_fma_f32 v31, v31, s88, -v21
    v_exp_f32 v28, v28
    v_exp_f32 v29, v29
    v_exp_f32 v30, v30
    v_exp_f32 v31, v31
    v_cvt_pk_bf16_f32 v32, v28, 0
    v_cvt_pk_bf16_f32 v36, 0, v28
    v_cvt_pk_bf16_f32 v33, v29, 0
    v_cvt_pk_bf16_f32 v37, 0, v29
    v_cvt_pk_bf16_f32 v34, v30, 0
    v_cvt_pk_bf16_f32 v38, 0, v30
    v_cvt_pk_bf16_f32 v35, v31, 0
    v_cvt_pk_bf16_f32 v39, 0, v31
    v_add_f32 v17, v17, v28
    v_add_f32 v17, v17, v29
    v_add_f32 v17, v17, v30
    v_add_f32 v17, v17, v31
    s_waitcnt vmcnt(4)
    v_dot2_f32_bf16 v8, v88, v32, v8
    v_dot2_f32_bf16 v9, v88, v36, v9
    v_dot2_f32_bf16 v10, v89, v32, v10
    v_dot2_f32_bf16 v11, v89, v36, v11
    v_dot2_f32_bf16 v12, v90, v32, v12
    v_dot2_f32_bf16 v13, v90, v36, v13
    v_dot2_f32_bf16 v14, v91, v32, v14
    v_dot2_f32_bf16 v15, v91, v36, v15
    v_dot2_f32_bf16 v8, v92, v33, v8
    v_dot2_f32_bf16 v9, v92, v37, v9
    v_dot2_f32_bf16 v10, v93, v33, v10
    v_dot2_f32_bf16 v11, v93, v37, v11
    v_dot2_f32_bf16 v12, v94, v33, v12
    v_dot2_f32_bf16 v13, v94, v37, v13
    v_dot2_f32_bf16 v14, v95, v33, v14
    v_dot2_f32_bf16 v15, v95, v37, v15
    v_dot2_f32_bf16 v8, v96, v34, v8
    v_dot2_f32_bf16 v9, v96, v38, v9
    v_dot2_f32_bf16 v10, v97, v34, v10
    v_dot2_f32_bf16 v11, v97, v38, v11
    v_dot2_f32_bf16 v12, v98, v34, v12
    v_dot2_f32_bf16 v13, v98, v38, v13
    v_dot2_f32_bf16 v14, v99, v34, v14
    v_dot2_f32_bf16 v15, v99, v38, v15
    v_dot2_f32_bf16 v8, v100, v35, v8
    v_dot2_f32_bf16 v9, v100, v39, v9
    v_dot2_f32_bf16 v10, v101, v35, v10
    v_dot2_f32_bf16 v11, v101, v39, v11
    v_dot2_f32_bf16 v12, v102, v35, v12
    v_dot2_f32_bf16 v13, v102, v39, v13
    v_dot2_f32_bf16 v14, v103, v35, v14
    v_dot2_f32_bf16 v15, v103, v39, v15
    buffer_load_dwordx4 v[88:91], v1, s[68:71], s77 offen offset:0 nt
    buffer_load_dwordx4 v[92:95], v1, s[68:71], s77 offen offset:1024 nt
    buffer_load_dwordx4 v[96:99], v1, s[68:71], s77 offen offset:2048 nt
    buffer_load_dwordx4 v[100:103], v1, s[68:71], s77 offen offset:3072 nt
    s_mov_b32 s80, s78
    v_add_u32 v236, s79, v239
    s_branch L_loop
L_bodyF:
    s_cmp_eq_u32 s76, 0x7f000000
    s_cbranch_scc1 L_done
    s_waitcnt vmcnt(4)
    s_mov_b64 exec, 1
    ds_add_rtn_u32 v20, v18, v19
    s_mov_b64 exec, -1
    v_dot2_f32_bf16 v24, v72, v4, 0
    v_dot2_f32_bf16 v25, v76, v4, 0
    v_dot2_f32_bf16 v26, v80, v4, 0
    v_dot2_f32_bf16 v27, v84, v4, 0
    v_dot2_f32_bf16 v24, v73, v5, v24
    v_dot2_f32_bf16 v25, v77, v5, v25
    v_dot2_f32_bf16 v26, v81, v5, v26
    v_dot2_f32_bf16 v27, v85, v5, v27
    v_dot2_f32_bf16 v24, v74, v6, v24
    v_dot2_f32_bf16 v25, v78, v6, v25
    v_dot2_f32_bf16 v26, v82, v6, v26
    v_dot2_f32_bf16 v27, v86, v6, v27
    v_dot2_f32_bf16 v24, v75, v7, v24
    v_dot2_f32_bf16 v25, v79, v7, v25
    v_dot2_f32_bf16 v26, v83, v7, v26
    v_dot2_f32_bf16 v27, v87, v7, v27
    s_waitcnt lgkmcnt(0)
    v_readfirstlane_b32 s82, v20
    s_lshr_b32 s3, s82, 3
    s_lshl_b32 s3, s3, 2
    v_mov_b32 v23, s3
    ds_read_b32 v20, v23 offset:16384
    v_add_f32_dpp v24, v24, v24 row_ror:8 row_mask:0xf bank_mask:0xf
    v_add_f32_dpp v25, v25, v25 row_ror:8 row_mask:0xf bank_mask:0xf
    v_add_f32_dpp v26, v26, v26 row_ror:8 row_mask:0xf bank_mask:0xf
    v_add_f32_dpp v27, v27, v27 row_ror:8 row_mask:0xf bank_mask:0xf
    v_add_f32_dpp v24, v24, v24 row_ror:4 row_mask:0xf bank_mask:0xf
    v_add_f32_dpp v25, v25, v25 row_ror:4 row_mask:0xf bank_mask:0xf
    v_add_f32_dpp v26, v26, v26 row_ror:4 row_mask:0xf bank_mask:0xf
    v_add_f32_dpp v27, v27, v27 row_ror:4 row_mask:0xf bank_mask:0xf
    v_add_f32_dpp v24, v24, v24 row_ror:2 row_mask:0xf bank_mask:0xf
    v_add_f32_dpp v25, v25, v25 row_ror:2 row_mask:0xf bank_mask:0xf
    v_add_f32_dpp v26, v26, v26 row_ror:2 row_mask:0xf bank_mask:0xf
    v_add_f32_dpp v27, v27, v27 row_ror:2 row_mask:0xf bank_mask:0xf
    v_add_f32_dpp v24, v24, v24 row_ror:1 row_mask:0xf bank_mask:0xf
    v_add_f32_dpp v25, v25, v25 row_ror:1 row_mask:0xf bank_mask:0xf
    v_add_f32_dpp v26, v26, v26 row_ror:1 row_mask:0xf bank_mask:0xf
    v_add_f32_dpp v27, v27, v27 row_ror:1 row_mask:0xf bank_mask:0xf
    v_cvt_pk_bf16_f32 v24, 0, v24
    v_cvt_pk_bf16_f32 v25, 0, v25
    v_cvt_pk_bf16_f32 v26, 0, v26
    v_cvt_pk_bf16_f32 v27, 0, v27
    v_mul_f32 v24, s89, v24
    v_mul_f32 v25, s89, v25
    v_mul_f32 v26, s89, v26
    v_mul_f32 v27, s89, v27
    v_cvt_pk_bf16_f32 v24, 0, v24
    v_cvt_pk_bf16_f32 v25, 0, v25
    v_cvt_pk_bf16_f32 v26, 0, v26
    v_cvt_pk_bf16_f32 v27, 0, v27
    v_max3_f32 v22, v16, v24, v25
    v_max3_f32 v22, v22, v26, v27
    v_mul_f32 v21, s88, v22
    v_fma_f32 v16, v16, s88, -v21
    v_fma_f32 v28, v24, s88, -v21
    v_fma_f32 v29, v25, s88, -v21
    v_fma_f32 v30, v26, s88, -v21
    v_fma_f32 v31, v27, s88, -v21
    v_exp_f32 v21, v16
    v_exp_f32 v28, v28
    v_exp_f32 v29, v29
    v_exp_f32 v30, v30
    v_exp_f32 v31, v31
    v_mov_b32 v16, v22
    v_mul_f32 v8, v8, v21
    v_mul_f32 v9, v9, v21
    v_mul_f32 v10, v10, v21
    v_mul_f32 v11, v11, v21
    v_mul_f32 v12, v12, v21
    v_mul_f32 v13, v13, v21
    v_mul_f32 v14, v14, v21
    v_mul_f32 v15, v15, v21
    v_fma_f32 v17, v17, v21, v28
    v_cvt_pk_bf16_f32 v32, v28, 0
    v_cvt_pk_bf16_f32 v36, 0, v28
    v_cvt_pk_bf16_f32 v33, v29, 0
    v_cvt_pk_bf16_f32 v37, 0, v29
    v_cvt_pk_bf16_f32 v34, v30, 0
    v_cvt_pk_bf16_f32 v38, 0, v30
    v_cvt_pk_bf16_f32 v35, v31, 0
    v_cvt_pk_bf16_f32 v39, 0, v31
    v_add_f32 v17, v17, v29
    v_add_f32 v17, v17, v30
    v_add_f32 v17, v17, v31
    s_waitcnt lgkmcnt(0)
    v_readfirstlane_b32 s3, v20
    s_and_b32 s7, s82, 7
    s_cmp_lt_i32 s3, 0
    s_cbranch_scc1 L_dyn
L_dynretF:
    s_lshr_b32 s78, s3, 29
    s_bfe_u32 s79, s3, 0x90014
    s_and_b32 s3, s3, 0x1fff
    s_lshl3_add_u32 s79, s79, s7
    s_lshl_b32 s79, s79, 6
    s_add_u32 s3, s3, s7
    s_cmp_eq_u32 s78, 2
    s_cselect_b32 s7, 0, s7
    s_cselect_b32 s77, 0, 4096
    s_add_u32 s3, s3, s7
    s_lshl_b32 s7, s3, 12
    s_cmp_lt_u32 s3, 4096
    s_cselect_b32 s76, s7, 0x7f000000
    s_add_u32 s77, s77, s76
    s_cmp_eq_u32 s78, 1
    s_cselect_b64 s[64:65], s[12:13], s[8:9]
    s_cmp_eq_u32 s78, 0
    s_cselect_b64 s[68:69], s[8:9], s[12:13]
    buffer_load_dwordx4 v[72:75], v1, s[64:67], s76 offen offset:0 nt
    buffer_load_dwordx4 v[76:79], v1, s[64:67], s76 offen offset:1024 nt
    buffer_load_dwordx4 v[80:83], v1, s[64:67], s76 offen offset:2048 nt
    buffer_load_dwordx4 v[84:87], v1, s[64:67], s76 offen offset:3072 nt
    s_waitcnt vmcnt(4)
    v_dot2_f32_bf16 v8, v88, v32, v8
    v_dot2_f32_bf16 v9, v88, v36, v9
    v_dot2_f32_bf16 v10, v89, v32, v10
    v_dot2_f32_bf16 v11, v89, v36, v11
    v_dot2_f32_bf16 v12, v90, v32, v12
    v_dot2_f32_bf16 v13, v90, v36, v13
    v_dot2_f32_bf16 v14, v91, v32, v14
    v_dot2_f32_bf16 v15, v91, v36, v15
    v_dot2_f32_bf16 v8, v92, v33, v8
    v_dot2_f32_bf16 v9, v92, v37, v9
    v_dot2_f32_bf16 v10, v93, v33, v10
    v_dot2_f32_bf16 v11, v93, v37, v11
    v_dot2_f32_bf16 v12, v94, v33, v12
    v_dot2_f32_bf16 v13, v94, v37, v13
    v_dot2_f32_bf16 v14, v95, v33, v14
    v_dot2_f32_bf16 v15, v95, v37, v15
    v_dot2_f32_bf16 v8, v96, v34, v8
    v_dot2_f32_bf16 v9, v96, v38, v9
    v_dot2_f32_bf16 v10, v97, v34, v10
    v_dot2_f32_bf16 v11, v97, v38, v11
    v_dot2_f32_bf16 v12, v98, v34, v12
    v_dot2_f32_bf16 v13, v98, v38, v13
    v_dot2_f32_bf16 v14, v99, v34, v14
    v_dot2_f32_bf16 v15, v99, v38, v15
    v_dot2_f32_bf16 v8, v100, v35, v8
    v_dot2_f32_bf16 v9, v100, v39, v9
    v_dot2_f32_bf16 v10, v101, v35, v10
    v_dot2_f32_bf16 v11, v101, v39, v11
    v_dot2_f32_bf16 v12, v102, v35, v12
    v_dot2_f32_bf16 v13, v102, v39, v13
    v_dot2_f32_bf16 v14, v103, v35, v14
    v_dot2_f32_bf16 v15, v103, v39, v15
    buffer_load_dwordx4 v[88:91], v1, s[68:71], s77 offen offset:0 nt
    buffer_load_dwordx4 v[92:95], v1, s[68:71], s77 offen offset:1024 nt
    buffer_load_dwordx4 v[96:99], v1, s[68:71], s77 offen offset:2048 nt
    buffer_load_dwordx4 v[100:103], v1, s[68:71], s77 offen offset:3072 nt
    s_mov_b32 s80, s78
    v_add_u32 v236, s79, v239
    s_branch L_loop
L_hook:
    s_nop 4
    s_cmp_lg_u32 s27, 0
    s_cbranch_scc1 L_hook1
    s_cmp_lg_u32 s90, 2
    s_cbranch_scc1 L_hook0
    s_cmp_lg_u32 s4, 0
    s_cbranch_scc1 L_hook0
    s_mov_b64 exec, 1
    buffer_atomic_add v19, off, s[48:51], 0
    s_mov_b64 exec, -1
L_hook0:
    s_nop 4
    s_cmp_lg_u32 s90, 3
    s_cbranch_scc1 L_hookt
    s_mov_b32 s3, 0x05040100
    s_mov_b32 s7, 0x07060302
    v_perm_b32 v234, v108, v104, s3
    v_perm_b32 v108, v108, v104, s7
    v_perm_b32 v104, v109, v105, s3
    v_perm_b32 v109, v109, v105, s7
    v_perm_b32 v105, v110, v106, s3
    v_perm_b32 v110, v110, v106, s7
    v_perm_b32 v106, v111, v107, s3
    v_perm_b32 v111, v111, v107, s7
    v_perm_b32 v107, v116, v112, s3
    v_perm_b32 v116, v116, v112, s7
    v_perm_b32 v112, v117, v113, s3
    v_perm_b32 v117, v117, v113, s7
    v_perm_b32 v113, v118, v114, s3
    v_perm_b32 v118, v118, v114, s7
    v_perm_b32 v114, v119, v115, s3
    v_perm_b32 v119, v119, v115, s7
    v_perm_b32 v115, v124, v120, s3
    v_perm_b32 v124, v124, v120, s7
    v_perm_b32 v120, v125, v121, s3
    v_perm_b32 v125, v125, v121, s7
    v_perm_b32 v121, v126, v122, s3
    v_perm_b32 v126, v126, v122, s7
    v_perm_b32 v122, v127, v123, s3
    v_perm_b32 v127, v127, v123, s7
    v_perm_b32 v123, v132, v128, s3
    v_perm_b32 v132, v132, v128, s7
    v_perm_b32 v128, v133, v129, s3
    v_perm_b32 v133, v133, v129, s7
    v_perm_b32 v129, v134, v130, s3
    v_perm_b32 v134, v134, v130, s7
    v_perm_b32 v130, v135, v131, s3
    v_perm_b32 v135, v135, v131, s7
    v_perm_b32 v131, v140, v136, s3
    v_perm_b32 v140, v140, v136, s7
    v_perm_b32 v136, v141, v137, s3
    v_perm_b32 v141, v141, v137, s7
    v_perm_b32 v137, v142, v138, s3
    v_perm_b32 v142, v142, v138, s7
    v_perm_b32 v138, v143, v139, s3
    v_perm_b32 v143, v143, v139, s7
    v_perm_b32 v139, v148, v144, s3
    v_perm_b32 v148, v148, v144, s7
    v_perm_b32 v144, v149, v145, s3
    v_perm_b32 v149, v149, v145, s7
    v_perm_b32 v145, v150, v146, s3
    v_perm_b32 v150, v150, v146, s7
    v_perm_b32 v146, v151, v147, s3
    v_perm_b32 v151, v151, v147, s7
    v_perm_b32 v147, v156, v152, s3
    v_perm_b32 v156, v156, v152, s7
    v_perm_b32 v152, v157, v153, s3
    v_perm_b32 v157, v157, v153, s7
    v_perm_b32 v153, v158, v154, s3
    v_perm_b32 v158, v158, v154, s7
    v_perm_b32 v154, v159, v155, s3
    v_perm_b32 v159, v159, v155, s7
    v_perm_b32 v155, v164, v160, s3
    v_perm_b32 v164, v164, v160, s7
    v_perm_b32 v160, v165, v161, s3
    v_perm_b32 v165, v165, v161, s7
    v_perm_b32 v161, v166, v162, s3
    v_perm_b32 v166, v166, v162, s7
    v_perm_b32 v162, v167, v163, s3
    v_perm_b32 v167, v167, v163, s7
    v_perm_b32 v163, v172, v168, s3
    v_perm_b32 v172, v172, v168, s7
    v_perm_b32 v168, v173, v169, s3
    v_perm_b32 v173, v173, v169, s7
    v_perm_b32 v169, v174, v170, s3
    v_perm_b32 v174, v174, v170, s7
    v_perm_b32 v170, v175, v171, s3
    v_perm_b32 v175, v175, v171, s7
    v_perm_b32 v171, v180, v176, s3
    v_perm_b32 v180, v180, v176, s7
    v_perm_b32 v176, v181, v177, s3
    v_perm_b32 v181, v181, v177, s7
    v_perm_b32 v177, v182, v178, s3
    v_perm_b32 v182, v182, v178, s7
    v_perm_b32 v178, v183, v179, s3
    v_perm_b32 v183, v183, v179, s7
    v_perm_b32 v179, v188, v184, s3
    v_perm_b32 v188, v188, v184, s7
    v_perm_b32 v184, v189, v185, s3
    v_perm_b32 v189, v189, v185, s7
    v_perm_b32 v185, v190, v186, s3
    v_perm_b32 v190, v190, v186, s7
    v_perm_b32 v186, v191, v187, s3
    v_perm_b32 v191, v191, v187, s7
    v_perm_b32 v187, v196, v192, s3
    v_perm_b32 v196, v196, v192, s7
    v_perm_b32 v192, v197, v193, s3
    v_perm_b32 v197, v197, v193, s7
    v_perm_b32 v193, v198, v194, s3
    v_perm_b32 v198, v198, v194, s7
    v_perm_b32 v194, v199, v195, s3
    v_perm_b32 v199, v199, v195, s7
    v_perm_b32 v195, v204, v200, s3
    v_perm_b32 v204, v204, v200, s7
    v_perm_b32 v200, v205, v201, s3
    v_perm_b32 v205, v205, v201, s7
    v_perm_b32 v201, v206, v202, s3
    v_perm_b32 v206, v206, v202, s7
    v_perm_b32 v202, v207, v203, s3
    v_perm_b32 v207, v207, v203, s7
    v_perm_b32 v203, v212, v208, s3
    v_perm_b32 v212, v212, v208, s7
    v_perm_b32 v208, v213, v209, s3
    v_perm_b32 v213, v213, v209, s7
    v_perm_b32 v209, v214, v210, s3
    v_perm_b32 v214, v214, v210, s7
    v_perm_b32 v210, v215, v211, s3
    v_perm_b32 v215, v215, v211, s7
    v_perm_b32 v211, v220, v216, s3
    v_perm_b32 v220, v220, v216, s7
    v_perm_b32 v216, v221, v217, s3
    v_perm_b32 v221, v221, v217, s7
    v_perm_b32 v217, v222, v218, s3
    v_perm_b32 v222, v222, v218, s7
    v_perm_b32 v218, v223, v219, s3
    v_perm_b32 v223, v223, v219, s7
    v_perm_b32 v219, v228, v224, s3
    v_perm_b32 v228, v228, v224, s7
    v_perm_b32 v224, v229, v225, s3
    v_perm_b32 v229, v229, v225, s7
    v_perm_b32 v225, v230, v226, s3
    v_perm_b32 v230, v230, v226, s7
    v_perm_b32 v226, v231, v227, s3
    v_perm_b32 v231, v231, v227, s7
    v_perm_b32 v227, v44, v40, s3
    v_perm_b32 v44, v44, v40, s7
    v_perm_b32 v40, v45, v41, s3
    v_perm_b32 v45, v45, v41, s7
    v_perm_b32 v41, v46, v42, s3
    v_perm_b32 v46, v46, v42, s7
    v_perm_b32 v42, v47, v43, s3
    v_perm_b32 v47, v47, v43, s7
    v_perm_b32 v43, v52, v48, s3
    v_perm_b32 v52, v52, v48, s7
    v_perm_b32 v48, v53, v49, s3
    v_perm_b32 v53, v53, v49, s7
    v_perm_b32 v49, v54, v50, s3
    v_perm_b32 v54, v54, v50, s7
    v_perm_b32 v50, v55, v51, s3
    v_perm_b32 v55, v55, v51, s7
    v_perm_b32 v51, v60, v56, s3
    v_perm_b32 v60, v60, v56, s7
    v_perm_b32 v56, v61, v57, s3
    v_perm_b32 v61, v61, v57, s7
    v_perm_b32 v57, v62, v58, s3
    v_perm_b32 v62, v62, v58, s7
    v_perm_b32 v58, v63, v59, s3
    v_perm_b32 v63, v63, v59, s7
    v_perm_b32 v59, v68, v64, s3
    v_perm_b32 v68, v68, v64, s7
    v_perm_b32 v64, v69, v65, s3
    v_perm_b32 v69, v69, v65, s7
    v_perm_b32 v65, v70, v66, s3
    v_perm_b32 v70, v70, v66, s7
    v_perm_b32 v66, v71, v67, s3
    v_perm_b32 v71, v71, v67, s7
    s_branch L_hookx
L_hookt:
    s_nop 4
    s_cmp_le_u32 s96, 0
    s_cbranch_scc1 L_hookx
    s_add_u32 s3, s4, 0
    s_lshl_b32 s3, s3, 6
    v_add_u32 v23, s3, v239
    v_dot2_f32_bf16 v32, v104, v4, 0
    v_dot2_f32_bf16 v33, v108, v4, 0
    v_dot2_f32_bf16 v34, v112, v4, 0
    v_dot2_f32_bf16 v35, v116, v4, 0
    v_dot2_f32_bf16 v32, v105, v5, v32
    v_dot2_f32_bf16 v33, v109, v5, v33
    v_dot2_f32_bf16 v34, v113, v5, v34
    v_dot2_f32_bf16 v35, v117, v5, v35
    v_dot2_f32_bf16 v32, v106, v6, v32
    v_dot2_f32_bf16 v33, v110, v6, v33
    v_dot2_f32_bf16 v34, v114, v6, v34
    v_dot2_f32_bf16 v35, v118, v6, v35
    v_dot2_f32_bf16 v32, v107, v7, v32
    v_dot2_f32_bf16 v33, v111, v7, v33
    v_dot2_f32_bf16 v34, v115, v7, v34
    v_dot2_f32_bf16 v35, v119, v7, v35
    v_add_f32_dpp v32, v32, v32 row_ror:8 row_mask:0xf bank_mask:0xf
    v_add_f32_dpp v33, v33, v33 row_ror:8 row_mask:0xf bank_mask:0xf
    v_add_f32_dpp v34, v34, v34 row_ror:8 row_mask:0xf bank_mask:0xf
    v_add_f32_dpp v35, v35, v35 row_ror:8 row_mask:0xf bank_mask:0xf
    v_add_f32_dpp v32, v32, v32 row_ror:4 row_mask:0xf bank_mask:0xf
    v_add_f32_dpp v33, v33, v33 row_ror:4 row_mask:0xf bank_mask:0xf
    v_add_f32_dpp v34, v34, v34 row_ror:4 row_mask:0xf bank_mask:0xf
    v_add_f32_dpp v35, v35, v35 row_ror:4 row_mask:0xf bank_mask:0xf
    v_add_f32_dpp v32, v32, v32 row_ror:2 row_mask:0xf bank_mask:0xf
    v_add_f32_dpp v33, v33, v33 row_ror:2 row_mask:0xf bank_mask:0xf
    v_add_f32_dpp v34, v34, v34 row_ror:2 row_mask:0xf bank_mask:0xf
    v_add_f32_dpp v35, v35, v35 row_ror:2 row_mask:0xf bank_mask:0xf
    v_add_f32_dpp v32, v32, v32 row_ror:1 row_mask:0xf bank_mask:0xf
    v_add_f32_dpp v33, v33, v33 row_ror:1 row_mask:0xf bank_mask:0xf
    v_add_f32_dpp v34, v34, v34 row_ror:1 row_mask:0xf bank_mask:0xf
    v_add_f32_dpp v35, v35, v35 row_ror:1 row_mask:0xf bank_mask:0xf
    v_cvt_pk_bf16_f32 v32, 0, v32
    v_cvt_pk_bf16_f32 v33, 0, v33
    v_cvt_pk_bf16_f32 v34, 0, v34
    v_cvt_pk_bf16_f32 v35, 0, v35
    v_mul_f32 v32, s89, v32
    v_mul_f32 v33, s89, v33
    v_mul_f32 v34, s89, v34
    v_mul_f32 v35, s89, v35
    v_max3_f32 v16, v16, v32, v33
    v_max3_f32 v16, v16, v34, v35
    v_dot2_f32_bf16 v36, v120, v4, 0
    v_dot2_f32_bf16 v37, v124, v4, 0
    v_dot2_f32_bf16 v38, v128, v4, 0
    v_dot2_f32_bf16 v39, v132, v4, 0
    v_dot2_f32_bf16 v36, v121, v5, v36
    v_dot2_f32_bf16 v37, v125, v5, v37
    v_dot2_f32_bf16 v38, v129, v5, v38
    v_dot2_f32_bf16 v39, v133, v5, v39
    v_dot2_f32_bf16 v36, v122, v6, v36
    v_dot2_f32_bf16 v37, v126, v6, v37
    v_dot2_f32_bf16 v38, v130, v6, v38
    v_dot2_f32_bf16 v39, v134, v6, v39
    v_dot2_f32_bf16 v36, v123, v7, v36
    v_dot2_f32_bf16 v37, v127, v7, v37
    v_dot2_f32_bf16 v38, v131, v7, v38
    v_dot2_f32_bf16 v39, v135, v7, v39
    v_add_f32_dpp v36, v36, v36 row_ror:8 row_mask:0xf bank_mask:0xf
    v_add_f32_dpp v37, v37, v37 row_ror:8 row_mask:0xf bank_mask:0xf
    v_add_f32_dpp v38, v38, v38 row_ror:8 row_mask:0xf bank_mask:0xf
    v_add_f32_dpp v39, v39, v39 row_ror:8 row_mask:0xf bank_mask:0xf
    v_add_f32_dpp v36, v36, v36 row_ror:4 row_mask:0xf bank_mask:0xf
    v_add_f32_dpp v37, v37, v37 row_ror:4 row_mask:0xf bank_mask:0xf
    v_add_f32_dpp v38, v38, v38 row_ror:4 row_mask:0xf bank_mask:0xf
    v_add_f32_dpp v39, v39, v39 row_ror:4 row_mask:0xf bank_mask:0xf
    v_add_f32_dpp v36, v36, v36 row_ror:2 row_mask:0xf bank_mask:0xf
    v_add_f32_dpp v37, v37, v37 row_ror:2 row_mask:0xf bank_mask:0xf
    v_add_f32_dpp v38, v38, v38 row_ror:2 row_mask:0xf bank_mask:0xf
    v_add_f32_dpp v39, v39, v39 row_ror:2 row_mask:0xf bank_mask:0xf
    v_add_f32_dpp v36, v36, v36 row_ror:1 row_mask:0xf bank_mask:0xf
    v_add_f32_dpp v37, v37, v37 row_ror:1 row_mask:0xf bank_mask:0xf
    v_add_f32_dpp v38, v38, v38 row_ror:1 row_mask:0xf bank_mask:0xf
    v_add_f32_dpp v39, v39, v39 row_ror:1 row_mask:0xf bank_mask:0xf
    v_cvt_pk_bf16_f32 v36, 0, v36
    v_cvt_pk_bf16_f32 v37, 0, v37
    v_cvt_pk_bf16_f32 v38, 0, v38
    v_cvt_pk_bf16_f32 v39, 0, v39
    v_mul_f32 v36, s89, v36
    v_mul_f32 v37, s89, v37
    v_mul_f32 v38, s89, v38
    v_mul_f32 v39, s89, v39
    v_max3_f32 v16, v16, v36, v37
    v_max3_f32 v16, v16, v38, v39
    v_cvt_pk_bf16_f32 v28, v32, v33
    v_cvt_pk_bf16_f32 v29, v34, v35
    v_cvt_pk_bf16_f32 v30, v36, v37
    v_cvt_pk_bf16_f32 v31, v38, v39
    ds_write_b128 v23, v[28:31]
    s_cmp_le_u32 s96, 1
    s_cbranch_scc1 L_hookx
    s_add_u32 s3, s4, 8
    s_lshl_b32 s3, s3, 6
    v_add_u32 v23, s3, v239
    v_dot2_f32_bf16 v32, v136, v4, 0
    v_dot2_f32_bf16 v33, v140, v4, 0
    v_dot2_f32_bf16 v34, v144, v4, 0
    v_dot2_f32_bf16 v35, v148, v4, 0
    v_dot2_f32_bf16 v32, v137, v5, v32
    v_dot2_f32_bf16 v33, v141, v5, v33
    v_dot2_f32_bf16 v34, v145, v5, v34
    v_dot2_f32_bf16 v35, v149, v5, v35
    v_dot2_f32_bf16 v32, v138, v6, v32
    v_dot2_f32_bf16 v33, v142, v6, v33
    v_dot2_f32_bf16 v34, v146, v6, v34
    v_dot2_f32_bf16 v35, v150, v6, v35
    v_dot2_f32_bf16 v32, v139, v7, v32
    v_dot2_f32_bf16 v33, v143, v7, v33
    v_dot2_f32_bf16 v34, v147, v7, v34
    v_dot2_f32_bf16 v35, v151, v7, v35
    v_add_f32_dpp v32, v32, v32 row_ror:8 row_mask:0xf bank_mask:0xf
    v_add_f32_dpp v33, v33, v33 row_ror:8 row_mask:0xf bank_mask:0xf
    v_add_f32_dpp v34, v34, v34 row_ror:8 row_mask:0xf bank_mask:0xf
    v_add_f32_dpp v35, v35, v35 row_ror:8 row_mask:0xf bank_mask:0xf
    v_add_f32_dpp v32, v32, v32 row_ror:4 row_mask:0xf bank_mask:0xf
    v_add_f32_dpp v33, v33, v33 row_ror:4 row_mask:0xf bank_mask:0xf
    v_add_f32_dpp v34, v34, v34 row_ror:4 row_mask:0xf bank_mask:0xf
    v_add_f32_dpp v35, v35, v35 row_ror:4 row_mask:0xf bank_mask:0xf
    v_add_f32_dpp v32, v32, v32 row_ror:2 row_mask:0xf bank_mask:0xf
    v_add_f32_dpp v33, v33, v33 row_ror:2 row_mask:0xf bank_mask:0xf
    v_add_f32_dpp v34, v34, v34 row_ror:2 row_mask:0xf bank_mask:0xf
    v_add_f32_dpp v35, v35, v35 row_ror:2 row_mask:0xf bank_mask:0xf
    v_add_f32_dpp v32, v32, v32 row_ror:1 row_mask:0xf bank_mask:0xf
    v_add_f32_dpp v33, v33, v33 row_ror:1 row_mask:0xf bank_mask:0xf
    v_add_f32_dpp v34, v34, v34 row_ror:1 row_mask:0xf bank_mask:0xf
    v_add_f32_dpp v35, v35, v35 row_ror:1 row_mask:0xf bank_mask:0xf
    v_cvt_pk_bf16_f32 v32, 0, v32
    v_cvt_pk_bf16_f32 v33, 0, v33
    v_cvt_pk_bf16_f32 v34, 0, v34
    v_cvt_pk_bf16_f32 v35, 0, v35
    v_mul_f32 v32, s89, v32
    v_mul_f32 v33, s89, v33
    v_mul_f32 v34, s89, v34
    v_mul_f32 v35, s89, v35
    v_max3_f32 v16, v16, v32, v33
    v_max3_f32 v16, v16, v34, v35
    v_dot2_f32_bf16 v36, v152, v4, 0
    v_dot2_f32_bf16 v37, v156, v4, 0
    v_dot2_f32_bf16 v38, v160, v4, 0
    v_dot2_f32_bf16 v39, v164, v4, 0
    v_dot2_f32_bf16 v36, v153, v5, v36
    v_dot2_f32_bf16 v37, v157, v5, v37
    v_dot2_f32_bf16 v38, v161, v5, v38
    v_dot2_f32_bf16 v39, v165, v5, v39
    v_dot2_f32_bf16 v36, v154, v6, v36
    v_dot2_f32_bf16 v37, v158, v6, v37
    v_dot2_f32_bf16 v38, v162, v6, v38
    v_dot2_f32_bf16 v39, v166, v6, v39
    v_dot2_f32_bf16 v36, v155, v7, v36
    v_dot2_f32_bf16 v37, v159, v7, v37
    v_dot2_f32_bf16 v38, v163, v7, v38
    v_dot2_f32_bf16 v39, v167, v7, v39
    v_add_f32_dpp v36, v36, v36 row_ror:8 row_mask:0xf bank_mask:0xf
    v_add_f32_dpp v37, v37, v37 row_ror:8 row_mask:0xf bank_mask:0xf
    v_add_f32_dpp v38, v38, v38 row_ror:8 row_mask:0xf bank_mask:0xf
    v_add_f32_dpp v39, v39, v39 row_ror:8 row_mask:0xf bank_mask:0xf
    v_add_f32_dpp v36, v36, v36 row_ror:4 row_mask:0xf bank_mask:0xf
    v_add_f32_dpp v37, v37, v37 row_ror:4 row_mask:0xf bank_mask:0xf
    v_add_f32_dpp v38, v38, v38 row_ror:4 row_mask:0xf bank_mask:0xf
    v_add_f32_dpp v39, v39, v39 row_ror:4 row_mask:0xf bank_mask:0xf
    v_add_f32_dpp v36, v36, v36 row_ror:2 row_mask:0xf bank_mask:0xf
    v_add_f32_dpp v37, v37, v37 row_ror:2 row_mask:0xf bank_mask:0xf
    v_add_f32_dpp v38, v38, v38 row_ror:2 row_mask:0xf bank_mask:0xf
    v_add_f32_dpp v39, v39, v39 row_ror:2 row_mask:0xf bank_mask:0xf
    v_add_f32_dpp v36, v36, v36 row_ror:1 row_mask:0xf bank_mask:0xf
    v_add_f32_dpp v37, v37, v37 row_ror:1 row_mask:0xf bank_mask:0xf
    v_add_f32_dpp v38, v38, v38 row_ror:1 row_mask:0xf bank_mask:0xf
    v_add_f32_dpp v39, v39, v39 row_ror:1 row_mask:0xf bank_mask:0xf
    v_cvt_pk_bf16_f32 v36, 0, v36
    v_cvt_pk_bf16_f32 v37, 0, v37
    v_cvt_pk_bf16_f32 v38, 0, v38
    v_cvt_pk_bf16_f32 v39, 0, v39
    v_mul_f32 v36, s89, v36
    v_mul_f32 v37, s89, v37
    v_mul_f32 v38, s89, v38
    v_mul_f32 v39, s89, v39
    v_max3_f32 v16, v16, v36, v37
    v_max3_f32 v16, v16, v38, v39
    v_cvt_pk_bf16_f32 v28, v32, v33
    v_cvt_pk_bf16_f32 v29, v34, v35
    v_cvt_pk_bf16_f32 v30, v36, v37
    v_cvt_pk_bf16_f32 v31, v38, v39
    ds_write_b128 v23, v[28:31]
    s_cmp_le_u32 s96, 2
    s_cbranch_scc1 L_hookx
    s_add_u32 s3, s4, 16
    s_lshl_b32 s3, s3, 6
    v_add_u32 v23, s3, v239
    v_dot2_f32_bf16 v32, v168, v4, 0
    v_dot2_f32_bf16 v33, v172, v4, 0
    v_dot2_f32_bf16 v34, v176, v4, 0
    v_dot2_f32_bf16 v35, v180, v4, 0
    v_dot2_f32_bf16 v32, v169, v5, v32
    v_dot2_f32_bf16 v33, v173, v5, v33
    v_dot2_f32_bf16 v34, v177, v5, v34
    v_dot2_f32_bf16 v35, v181, v5, v35
    v_dot2_f32_bf16 v32, v170, v6, v32
    v_dot2_f32_bf16 v33, v174, v6, v33
    v_dot2_f32_bf16 v34, v178, v6, v34
    v_dot2_f32_bf16 v35, v182, v6, v35
    v_dot2_f32_bf16 v32, v171, v7, v32
    v_dot2_f32_bf16 v33, v175, v7, v33
    v_dot2_f32_bf16 v34, v179, v7, v34
    v_dot2_f32_bf16 v35, v183, v7, v35
    v_add_f32_dpp v32, v32, v32 row_ror:8 row_mask:0xf bank_mask:0xf
    v_add_f32_dpp v33, v33, v33 row_ror:8 row_mask:0xf bank_mask:0xf
    v_add_f32_dpp v34, v34, v34 row_ror:8 row_mask:0xf bank_mask:0xf
    v_add_f32_dpp v35, v35, v35 row_ror:8 row_mask:0xf bank_mask:0xf
    v_add_f32_dpp v32, v32, v32 row_ror:4 row_mask:0xf bank_mask:0xf
    v_add_f32_dpp v33, v33, v33 row_ror:4 row_mask:0xf bank_mask:0xf
    v_add_f32_dpp v34, v34, v34 row_ror:4 row_mask:0xf bank_mask:0xf
    v_add_f32_dpp v35, v35, v35 row_ror:4 row_mask:0xf bank_mask:0xf
    v_add_f32_dpp v32, v32, v32 row_ror:2 row_mask:0xf bank_mask:0xf
    v_add_f32_dpp v33, v33, v33 row_ror:2 row_mask:0xf bank_mask:0xf
    v_add_f32_dpp v34, v34, v34 row_ror:2 row_mask:0xf bank_mask:0xf
    v_add_f32_dpp v35, v35, v35 row_ror:2 row_mask:0xf bank_mask:0xf
    v_add_f32_dpp v32, v32, v32 row_ror:1 row_mask:0xf bank_mask:0xf
    v_add_f32_dpp v33, v33, v33 row_ror:1 row_mask:0xf bank_mask:0xf
    v_add_f32_dpp v34, v34, v34 row_ror:1 row_mask:0xf bank_mask:0xf
    v_add_f32_dpp v35, v35, v35 row_ror:1 row_mask:0xf bank_mask:0xf
    v_cvt_pk_bf16_f32 v32, 0, v32
    v_cvt_pk_bf16_f32 v33, 0, v33
    v_cvt_pk_bf16_f32 v34, 0, v34
    v_cvt_pk_bf16_f32 v35, 0, v35
    v_mul_f32 v32, s89, v32
    v_mul_f32 v33, s89, v33
    v_mul_f32 v34, s89, v34
    v_mul_f32 v35, s89, v35
    v_max3_f32 v16, v16, v32, v33
    v_max3_f32 v16, v16, v34, v35
    v_dot2_f32_bf16 v36, v184, v4, 0
    v_dot2_f32_bf16 v37, v188, v4, 0
    v_dot2_f32_bf16 v38, v192, v4, 0
    v_dot2_f32_bf16 v39, v196, v4, 0
    v_dot2_f32_bf16 v36, v185, v5, v36
    v_dot2_f32_bf16 v37, v189, v5, v37
    v_dot2_f32_bf16 v38, v193, v5, v38
    v_dot2_f32_bf16 v39, v197, v5, v39
    v_dot2_f32_bf16 v36, v186, v6, v36
    v_dot2_f32_bf16 v37, v190, v6, v37
    v_dot2_f32_bf16 v38, v194, v6, v38
    v_dot2_f32_bf16 v39, v198, v6, v39
    v_dot2_f32_bf16 v36, v187, v7, v36
    v_dot2_f32_bf16 v37, v191, v7, v37
    v_dot2_f32_bf16 v38, v195, v7, v38
    v_dot2_f32_bf16 v39, v199, v7, v39
    v_add_f32_dpp v36, v36, v36 row_ror:8 row_mask:0xf bank_mask:0xf
    v_add_f32_dpp v37, v37, v37 row_ror:8 row_mask:0xf bank_mask:0xf
    v_add_f32_dpp v38, v38, v38 row_ror:8 row_mask:0xf bank_mask:0xf
    v_add_f32_dpp v39, v39, v39 row_ror:8 row_mask:0xf bank_mask:0xf
    v_add_f32_dpp v36, v36, v36 row_ror:4 row_mask:0xf bank_mask:0xf
    v_add_f32_dpp v37, v37, v37 row_ror:4 row_mask:0xf bank_mask:0xf
    v_add_f32_dpp v38, v38, v38 row_ror:4 row_mask:0xf bank_mask:0xf
    v_add_f32_dpp v39, v39, v39 row_ror:4 row_mask:0xf bank_mask:0xf
    v_add_f32_dpp v36, v36, v36 row_ror:2 row_mask:0xf bank_mask:0xf
    v_add_f32_dpp v37, v37, v37 row_ror:2 row_mask:0xf bank_mask:0xf
    v_add_f32_dpp v38, v38, v38 row_ror:2 row_mask:0xf bank_mask:0xf
    v_add_f32_dpp v39, v39, v39 row_ror:2 row_mask:0xf bank_mask:0xf
    v_add_f32_dpp v36, v36, v36 row_ror:1 row_mask:0xf bank_mask:0xf
    v_add_f32_dpp v37, v37, v37 row_ror:1 row_mask:0xf bank_mask:0xf
    v_add_f32_dpp v38, v38, v38 row_ror:1 row_mask:0xf bank_mask:0xf
    v_add_f32_dpp v39, v39, v39 row_ror:1 row_mask:0xf bank_mask:0xf
    v_cvt_pk_bf16_f32 v36, 0, v36
    v_cvt_pk_bf16_f32 v37, 0, v37
    v_cvt_pk_bf16_f32 v38, 0, v38
    v_cvt_pk_bf16_f32 v39, 0, v39
    v_mul_f32 v36, s89, v36
    v_mul_f32 v37, s89, v37
    v_mul_f32 v38, s89, v38
    v_mul_f32 v39, s89, v39
    v_max3_f32 v16, v16, v36, v37
    v_max3_f32 v16, v16, v38, v39
    v_cvt_pk_bf16_f32 v28, v32, v33
    v_cvt_pk_bf16_f32 v29, v34, v35
    v_cvt_pk_bf16_f32 v30, v36, v37
    v_cvt_pk_bf16_f32 v31, v38, v39
    ds_write_b128 v23, v[28:31]
    s_cmp_le_u32 s96, 3
    s_cbranch_scc1 L_hookx
    s_add_u32 s3, s4, 24
    s_lshl_b32 s3, s3, 6
    v_add_u32 v23, s3, v239
    v_dot2_f32_bf16 v32, v200, v4, 0
    v_dot2_f32_bf16 v33, v204, v4, 0
    v_dot2_f32_bf16 v34, v208, v4, 0
    v_dot2_f32_bf16 v35, v212, v4, 0
    v_dot2_f32_bf16 v32, v201, v5, v32
    v_dot2_f32_bf16 v33, v205, v5, v33
    v_dot2_f32_bf16 v34, v209, v5, v34
    v_dot2_f32_bf16 v35, v213, v5, v35
    v_dot2_f32_bf16 v32, v202, v6, v32
    v_dot2_f32_bf16 v33, v206, v6, v33
    v_dot2_f32_bf16 v34, v210, v6, v34
    v_dot2_f32_bf16 v35, v214, v6, v35
    v_dot2_f32_bf16 v32, v203, v7, v32
    v_dot2_f32_bf16 v33, v207, v7, v33
    v_dot2_f32_bf16 v34, v211, v7, v34
    v_dot2_f32_bf16 v35, v215, v7, v35
    v_add_f32_dpp v32, v32, v32 row_ror:8 row_mask:0xf bank_mask:0xf
    v_add_f32_dpp v33, v33, v33 row_ror:8 row_mask:0xf bank_mask:0xf
    v_add_f32_dpp v34, v34, v34 row_ror:8 row_mask:0xf bank_mask:0xf
    v_add_f32_dpp v35, v35, v35 row_ror:8 row_mask:0xf bank_mask:0xf
    v_add_f32_dpp v32, v32, v32 row_ror:4 row_mask:0xf bank_mask:0xf
    v_add_f32_dpp v33, v33, v33 row_ror:4 row_mask:0xf bank_mask:0xf
    v_add_f32_dpp v34, v34, v34 row_ror:4 row_mask:0xf bank_mask:0xf
    v_add_f32_dpp v35, v35, v35 row_ror:4 row_mask:0xf bank_mask:0xf
    v_add_f32_dpp v32, v32, v32 row_ror:2 row_mask:0xf bank_mask:0xf
    v_add_f32_dpp v33, v33, v33 row_ror:2 row_mask:0xf bank_mask:0xf
    v_add_f32_dpp v34, v34, v34 row_ror:2 row_mask:0xf bank_mask:0xf
    v_add_f32_dpp v35, v35, v35 row_ror:2 row_mask:0xf bank_mask:0xf
    v_add_f32_dpp v32, v32, v32 row_ror:1 row_mask:0xf bank_mask:0xf
    v_add_f32_dpp v33, v33, v33 row_ror:1 row_mask:0xf bank_mask:0xf
    v_add_f32_dpp v34, v34, v34 row_ror:1 row_mask:0xf bank_mask:0xf
    v_add_f32_dpp v35, v35, v35 row_ror:1 row_mask:0xf bank_mask:0xf
    v_cvt_pk_bf16_f32 v32, 0, v32
    v_cvt_pk_bf16_f32 v33, 0, v33
    v_cvt_pk_bf16_f32 v34, 0, v34
    v_cvt_pk_bf16_f32 v35, 0, v35
    v_mul_f32 v32, s89, v32
    v_mul_f32 v33, s89, v33
    v_mul_f32 v34, s89, v34
    v_mul_f32 v35, s89, v35
    v_max3_f32 v16, v16, v32, v33
    v_max3_f32 v16, v16, v34, v35
    v_dot2_f32_bf16 v36, v216, v4, 0
    v_dot2_f32_bf16 v37, v220, v4, 0
    v_dot2_f32_bf16 v38, v224, v4, 0
    v_dot2_f32_bf16 v39, v228, v4, 0
    v_dot2_f32_bf16 v36, v217, v5, v36
    v_dot2_f32_bf16 v37, v221, v5, v37
    v_dot2_f32_bf16 v38, v225, v5, v38
    v_dot2_f32_bf16 v39, v229, v5, v39
    v_dot2_f32_bf16 v36, v218, v6, v36
    v_dot2_f32_bf16 v37, v222, v6, v37
    v_dot2_f32_bf16 v38, v226, v6, v38
    v_dot2_f32_bf16 v39, v230, v6, v39
    v_dot2_f32_bf16 v36, v219, v7, v36
    v_dot2_f32_bf16 v37, v223, v7, v37
    v_dot2_f32_bf16 v38, v227, v7, v38
    v_dot2_f32_bf16 v39, v231, v7, v39
    v_add_f32_dpp v36, v36, v36 row_ror:8 row_mask:0xf bank_mask:0xf
    v_add_f32_dpp v37, v37, v37 row_ror:8 row_mask:0xf bank_mask:0xf
    v_add_f32_dpp v38, v38, v38 row_ror:8 row_mask:0xf bank_mask:0xf
    v_add_f32_dpp v39, v39, v39 row_ror:8 row_mask:0xf bank_mask:0xf
    v_add_f32_dpp v36, v36, v36 row_ror:4 row_mask:0xf bank_mask:0xf
    v_add_f32_dpp v37, v37, v37 row_ror:4 row_mask:0xf bank_mask:0xf
    v_add_f32_dpp v38, v38, v38 row_ror:4 row_mask:0xf bank_mask:0xf
    v_add_f32_dpp v39, v39, v39 row_ror:4 row_mask:0xf bank_mask:0xf
    v_add_f32_dpp v36, v36, v36 row_ror:2 row_mask:0xf bank_mask:0xf
    v_add_f32_dpp v37, v37, v37 row_ror:2 row_mask:0xf bank_mask:0xf
    v_add_f32_dpp v38, v38, v38 row_ror:2 row_mask:0xf bank_mask:0xf
    v_add_f32_dpp v39, v39, v39 row_ror:2 row_mask:0xf bank_mask:0xf
    v_add_f32_dpp v36, v36, v36 row_ror:1 row_mask:0xf bank_mask:0xf
    v_add_f32_dpp v37, v37, v37 row_ror:1 row_mask:0xf bank_mask:0xf
    v_add_f32_dpp v38, v38, v38 row_ror:1 row_mask:0xf bank_mask:0xf
    v_add_f32_dpp v39, v39, v39 row_ror:1 row_mask:0xf bank_mask:0xf
    v_cvt_pk_bf16_f32 v36, 0, v36
    v_cvt_pk_bf16_f32 v37, 0, v37
    v_cvt_pk_bf16_f32 v38, 0, v38
    v_cvt_pk_bf16_f32 v39, 0, v39
    v_mul_f32 v36, s89, v36
    v_mul_f32 v37, s89, v37
    v_mul_f32 v38, s89, v38
    v_mul_f32 v39, s89, v39
    v_max3_f32 v16, v16, v36, v37
    v_max3_f32 v16, v16, v38, v39
    v_cvt_pk_bf16_f32 v28, v32, v33
    v_cvt_pk_bf16_f32 v29, v34, v35
    v_cvt_pk_bf16_f32 v30, v36, v37
    v_cvt_pk_bf16_f32 v31, v38, v39
    ds_write_b128 v23, v[28:31]
    s_cmp_le_u32 s96, 4
    s_cbranch_scc1 L_hookx
    s_add_u32 s3, s4, 32
    s_lshl_b32 s3, s3, 6
    v_add_u32 v23, s3, v239
    v_dot2_f32_bf16 v32, v40, v4, 0
    v_dot2_f32_bf16 v33, v44, v4, 0
    v_dot2_f32_bf16 v34, v48, v4, 0
    v_dot2_f32_bf16 v35, v52, v4, 0
    v_dot2_f32_bf16 v32, v41, v5, v32
    v_dot2_f32_bf16 v33, v45, v5, v33
    v_dot2_f32_bf16 v34, v49, v5, v34
    v_dot2_f32_bf16 v35, v53, v5, v35
    v_dot2_f32_bf16 v32, v42, v6, v32
    v_dot2_f32_bf16 v33, v46, v6, v33
    v_dot2_f32_bf16 v34, v50, v6, v34
    v_dot2_f32_bf16 v35, v54, v6, v35
    v_dot2_f32_bf16 v32, v43, v7, v32
    v_dot2_f32_bf16 v33, v47, v7, v33
    v_dot2_f32_bf16 v34, v51, v7, v34
    v_dot2_f32_bf16 v35, v55, v7, v35
    v_add_f32_dpp v32, v32, v32 row_ror:8 row_mask:0xf bank_mask:0xf
    v_add_f32_dpp v33, v33, v33 row_ror:8 row_mask:0xf bank_mask:0xf
    v_add_f32_dpp v34, v34, v34 row_ror:8 row_mask:0xf bank_mask:0xf
    v_add_f32_dpp v35, v35, v35 row_ror:8 row_mask:0xf bank_mask:0xf
    v_add_f32_dpp v32, v32, v32 row_ror:4 row_mask:0xf bank_mask:0xf
    v_add_f32_dpp v33, v33, v33 row_ror:4 row_mask:0xf bank_mask:0xf
    v_add_f32_dpp v34, v34, v34 row_ror:4 row_mask:0xf bank_mask:0xf
    v_add_f32_dpp v35, v35, v35 row_ror:4 row_mask:0xf bank_mask:0xf
    v_add_f32_dpp v32, v32, v32 row_ror:2 row_mask:0xf bank_mask:0xf
    v_add_f32_dpp v33, v33, v33 row_ror:2 row_mask:0xf bank_mask:0xf
    v_add_f32_dpp v34, v34, v34 row_ror:2 row_mask:0xf bank_mask:0xf
    v_add_f32_dpp v35, v35, v35 row_ror:2 row_mask:0xf bank_mask:0xf
    v_add_f32_dpp v32, v32, v32 row_ror:1 row_mask:0xf bank_mask:0xf
    v_add_f32_dpp v33, v33, v33 row_ror:1 row_mask:0xf bank_mask:0xf
    v_add_f32_dpp v34, v34, v34 row_ror:1 row_mask:0xf bank_mask:0xf
    v_add_f32_dpp v35, v35, v35 row_ror:1 row_mask:0xf bank_mask:0xf
    v_cvt_pk_bf16_f32 v32, 0, v32
    v_cvt_pk_bf16_f32 v33, 0, v33
    v_cvt_pk_bf16_f32 v34, 0, v34
    v_cvt_pk_bf16_f32 v35, 0, v35
    v_mul_f32 v32, s89, v32
    v_mul_f32 v33, s89, v33
    v_mul_f32 v34, s89, v34
    v_mul_f32 v35, s89, v35
    v_max3_f32 v16, v16, v32, v33
    v_max3_f32 v16, v16, v34, v35
    v_dot2_f32_bf16 v36, v56, v4, 0
    v_dot2_f32_bf16 v37, v60, v4, 0
    v_dot2_f32_bf16 v38, v64, v4, 0
    v_dot2_f32_bf16 v39, v68, v4, 0
    v_dot2_f32_bf16 v36, v57, v5, v36
    v_dot2_f32_bf16 v37, v61, v5, v37
    v_dot2_f32_bf16 v38, v65, v5, v38
    v_dot2_f32_bf16 v39, v69, v5, v39
    v_dot2_f32_bf16 v36, v58, v6, v36
    v_dot2_f32_bf16 v37, v62, v6, v37
    v_dot2_f32_bf16 v38, v66, v6, v38
    v_dot2_f32_bf16 v39, v70, v6, v39
    v_dot2_f32_bf16 v36, v59, v7, v36
    v_dot2_f32_bf16 v37, v63, v7, v37
    v_dot2_f32_bf16 v38, v67, v7, v38
    v_dot2_f32_bf16 v39, v71, v7, v39
    v_add_f32_dpp v36, v36, v36 row_ror:8 row_mask:0xf bank_mask:0xf
    v_add_f32_dpp v37, v37, v37 row_ror:8 row_mask:0xf bank_mask:0xf
    v_add_f32_dpp v38, v38, v38 row_ror:8 row_mask:0xf bank_mask:0xf
    v_add_f32_dpp v39, v39, v39 row_ror:8 row_mask:0xf bank_mask:0xf
    v_add_f32_dpp v36, v36, v36 row_ror:4 row_mask:0xf bank_mask:0xf
    v_add_f32_dpp v37, v37, v37 row_ror:4 row_mask:0xf bank_mask:0xf
    v_add_f32_dpp v38, v38, v38 row_ror:4 row_mask:0xf bank_mask:0xf
    v_add_f32_dpp v39, v39, v39 row_ror:4 row_mask:0xf bank_mask:0xf
    v_add_f32_dpp v36, v36, v36 row_ror:2 row_mask:0xf bank_mask:0xf
    v_add_f32_dpp v37, v37, v37 row_ror:2 row_mask:0xf bank_mask:0xf
    v_add_f32_dpp v38, v38, v38 row_ror:2 row_mask:0xf bank_mask:0xf
    v_add_f32_dpp v39, v39, v39 row_ror:2 row_mask:0xf bank_mask:0xf
    v_add_f32_dpp v36, v36, v36 row_ror:1 row_mask:0xf bank_mask:0xf
    v_add_f32_dpp v37, v37, v37 row_ror:1 row_mask:0xf bank_mask:0xf
    v_add_f32_dpp v38, v38, v38 row_ror:1 row_mask:0xf bank_mask:0xf
    v_add_f32_dpp v39, v39, v39 row_ror:1 row_mask:0xf bank_mask:0xf
    v_cvt_pk_bf16_f32 v36, 0, v36
    v_cvt_pk_bf16_f32 v37, 0, v37
    v_cvt_pk_bf16_f32 v38, 0, v38
    v_cvt_pk_bf16_f32 v39, 0, v39
    v_mul_f32 v36, s89, v36
    v_mul_f32 v37, s89, v37
    v_mul_f32 v38, s89, v38
    v_mul_f32 v39, s89, v39
    v_max3_f32 v16, v16, v36, v37
    v_max3_f32 v16, v16, v38, v39
    v_cvt_pk_bf16_f32 v28, v32, v33
    v_cvt_pk_bf16_f32 v29, v34, v35
    v_cvt_pk_bf16_f32 v30, v36, v37
    v_cvt_pk_bf16_f32 v31, v38, v39
    ds_write_b128 v23, v[28:31]
L_hookx:
    s_nop 4
    s_mov_b32 s27, 1
    s_mov_b32 s92, s95
    s_branch L_loop2
L_hook1:
    s_nop 4
    s_mov_b32 s3, 0
    s_atomic_add s3, s[40:41], 0 glc
    s_waitcnt lgkmcnt(0)
    s_and_b32 s7, s3, 0x3ff
    s_cmp_ge_u32 s7, 0x120
    s_cbranch_scc1 L_hook1_ok
    s_add_u32 s94, s94, 1
    s_cmp_lt_u32 s94, 0x40000
    s_cbranch_scc1 L_hook1
    s_branch L_end
L_hook1_ok:
    s_nop 4
    ds_write_b32 v18, v19 offset:4
    s_waitcnt lgkmcnt(0)
    s_mov_b32 s92, 0x7fffffff
    s_andn2_b32 s3, s3, 0x3ff
    s_lshl_b32 s7, s1, 5
    s_cmp_eq_u32 s3, s7
    s_cselect_b32 s0, 1, 0
    s_branch L_loop2
L_dyn:
    s_cmp_lg_u32 s3, -1
    s_cbranch_scc1 L_dynf
    ds_read_b32 v20, v23 offset:16384
    s_add_u32 s94, s94, 1
    s_cmp_ge_u32 s94, 0x400000
    s_cbranch_scc1 L_end
    s_waitcnt lgkmcnt(0)
    v_readfirstlane_b32 s3, v20
    s_cmp_lt_i32 s3, 0
    s_cbranch_scc1 L_dyn
    s_branch L_dynret
L_dynf:
    s_bitset0_b32 s3, 31
    s_cmp_lg_u32 s7, 0
    s_cbranch_scc1 L_dynret
    s_mov_b32 s85, s3
    s_cmp_lg_u32 s101, 0
    s_cbranch_scc1 L_dyngo
    ds_read_b32 v28, v18 offset:4
    s_waitcnt lgkmcnt(0)
    v_cmp_eq_u32 vcc, 0, v28
    s_cbranch_vccz L_dynw_ok
L_dynw:
    s_nop 4
    s_mov_b32 s3, 0
    s_atomic_add s3, s[40:41], 0 glc
    s_waitcnt lgkmcnt(0)
    s_and_b32 s7, s3, 0x3ff
    s_cmp_ge_u32 s7, 0x120
    s_cbranch_scc1 L_dynw_ok
    s_add_u32 s94, s94, 1
    s_cmp_lt_u32 s94, 0x40000
    s_cbranch_scc1 L_dynw
    s_branch L_end
L_dynw_ok:
    s_nop 4
    s_mov_b32 s101, 1
L_dyngo:
    s_cmp_lt_u32 s85, 0x20000000
    s_cselect_b32 s3, 0, 4
    s_add_u32 s3, s3, s93
    s_mov_b32 s81, 1
    s_atomic_add s81, s[42:43], s3 glc
    v_lshl_add_u32 v23, v2, 2, v23
    s_cmp_lt_u32 s85, 0x20000000
    s_cbranch_scc1 L_dynK
    v_lshlrev_b32 v24, 3, v2
    s_waitcnt lgkmcnt(0)
    s_add_u32 s3, s81, 68
    s_mov_b32 s84, 1
    s_mul_i32 s7, s81, 2
    s_add_u32 s7, s7, 40
    s_cmp_lt_u32 s81, 28
    s_cselect_b32 s3, s7, s3
    s_cselect_b32 s84, 2, s84
    s_mul_i32 s7, s81, 4
    s_add_u32 s7, s7, 16
    s_cmp_lt_u32 s81, 12
    s_cselect_b32 s3, s7, s3
    s_cselect_b32 s84, 4, s84
    s_mul_i32 s7, s81, 8
    s_add_u32 s7, s7, 0
    s_cmp_lt_u32 s81, 4
    s_cselect_b32 s3, s7, s3
    s_cselect_b32 s84, 8, s84
    s_sub_u32 s7, s84, 1
    s_cmp_lt_u32 s3, 112
    s_cselect_b32 s3, s3, 112
    s_cselect_b32 s84, s84, 8
    s_cselect_b32 s7, s7, 64
    s_lshl_b32 s3, s3, 3
    s_add_u32 s3, s3, 0x40000c80
L_dynpub:
    v_add_u32 v24, s3, v24
    v_or_b32 v25, 0x80000000, v24
    v_cmp_eq_u32 vcc, s7, v2
    s_nop 1
    v_cndmask_b32 v24, v24, v25, vcc
    s_bfm_b64 exec, s84, 0
    ds_write_b32 v23, v24 offset:16388
    s_mov_b64 exec, -1
L_dynout:
    s_mov_b32 s3, s85
    s_mov_b32 s7, 0
L_dynret:
    s_cmp_eq_u32 s80, 0
    s_cbranch_scc1 L_dynretK
    s_cmp_eq_u32 s80, 1
    s_cbranch_scc1 L_dynretV
    s_branch L_dynretF
L_dynK:
    v_mul_u32_u24 v24, 0x100010, v2
    s_waitcnt lgkmcnt(0)
    s_add_u32 s3, s81, 53
    s_mov_b32 s84, 1
    s_mul_i32 s7, s81, 2
    s_add_u32 s7, s7, 34
    s_cmp_lt_u32 s81, 19
    s_cselect_b32 s3, s7, s3
    s_cselect_b32 s84, 2, s84
    s_mul_i32 s7, s81, 4
    s_add_u32 s7, s7, 12
    s_cmp_lt_u32 s81, 11
    s_cselect_b32 s3, s7, s3
    s_cselect_b32 s84, 4, s84
    s_mul_i32 s7, s81, 8
    s_add_u32 s7, s7, 0
    s_cmp_lt_u32 s81, 3
    s_cselect_b32 s3, s7, s3
    s_cselect_b32 s84, 8, s84
    s_sub_u32 s7, s84, 1
    s_cmp_lt_u32 s3, 74
    s_cbranch_scc0 L_dynV
    s_lshl_b32 s3, s3, 4
    s_add_u32 s3, s3, 0x1007e0
    s_and_b32 s81, s85, 0x1ff00000
    s_add_u32 s3, s3, s81
    s_branch L_dynpub
L_dynV:
    s_lshr_b32 s84, s85, 20
    v_lshlrev_b32 v29, 2, v2
    ds_read_b32 v24, v29 offset:16384
    v_add_u32 v28, 0, v2
    s_waitcnt lgkmcnt(0)
    v_and_b32 v24, 0x7fffffff, v24
    v_or_b32 v24, 0x20000000, v24
    v_or_b32 v25, 0x80000000, v24
    v_cmp_eq_u32 vcc, s84, v28
    s_nop 1
    v_cndmask_b32 v24, v24, v25, vcc
    v_cmp_ge_u32 vcc, s84, v28
    s_nop 4
    s_mov_b64 exec, vcc
    ds_write_b32 v23, v24 offset:16388
    s_mov_b64 exec, -1
    ds_read_b32 v24, v29 offset:16640
    v_add_u32 v28, 64, v2
    s_waitcnt lgkmcnt(0)
    v_and_b32 v24, 0x7fffffff, v24
    v_or_b32 v24, 0x20000000, v24
    v_or_b32 v25, 0x80000000, v24
    v_cmp_eq_u32 vcc, s84, v28
    s_nop 1
    v_cndmask_b32 v24, v24, v25, vcc
    v_cmp_ge_u32 vcc, s84, v28
    s_nop 4
    s_mov_b64 exec, vcc
    ds_write_b32 v23, v24 offset:16644
    s_mov_b64 exec, -1
    s_branch L_dynout
L_done:
    s_nop 4
    s_waitcnt lgkmcnt(0)
    s_cmp_lt_u32 s92, 0x10000
    s_cbranch_scc0 L_done2
L_hook2:
    s_nop 4
    s_mov_b32 s3, 0
    s_atomic_add s3, s[40:41], 0 glc
    s_waitcnt lgkmcnt(0)
    s_and_b32 s7, s3, 0x3ff
    s_cmp_ge_u32 s7, 0x120
    s_cbranch_scc1 L_hook2_ok
    s_add_u32 s94, s94, 1
    s_cmp_lt_u32 s94, 0x40000
    s_cbranch_scc1 L_hook2
    s_branch L_end
L_hook2_ok:
    s_nop 4
    ds_write_b32 v18, v19 offset:4
    s_waitcnt lgkmcnt(0)
    s_mov_b32 s92, 0x7fffffff
    s_andn2_b32 s3, s3, 0x3ff
    s_lshl_b32 s7, s1, 5
    s_cmp_eq_u32 s3, s7
    s_cselect_b32 s0, 1, 0
L_done2:
    s_nop 4
    s_mov_b32 s101, 0x7f000000
    s_waitcnt vmcnt(0)
    v_mov_b32 v72, v16
    v_mov_b32 v74, v72
    s_nop 1
    v_permlane16_swap_b32 v72, v74
    v_max_f32 v72, v72, v74
    v_mov_b32 v74, v72
    s_nop 1
    v_permlane32_swap_b32 v72, v74
    v_max_f32 v72, v72, v74
    v_sub_f32 v74, v16, v72
    v_mul_f32 v74, s88, v74
    v_exp_f32 v74, v74
    s_nop 0
    v_mul_f32 v73, v17, v74
    v_pk_mul_f32 v[80:81], v[8:9], v[74:75] op_sel_hi:[1,0]
    v_pk_mul_f32 v[82:83], v[10:11], v[74:75] op_sel_hi:[1,0]
    v_pk_mul_f32 v[84:85], v[12:13], v[74:75] op_sel_hi:[1,0]
    v_pk_mul_f32 v[86:87], v[14:15], v[74:75] op_sel_hi:[1,0]
    v_mov_b32 v75, v73
    v_permlane32_swap_b32 v80, v84
    v_permlane32_swap_b32 v81, v85
    v_permlane32_swap_b32 v82, v86
    v_permlane32_swap_b32 v83, v87
    v_permlane32_swap_b32 v73, v75
    v_pk_add_f32 v[80:81], v[80:81], v[84:85]
    v_pk_add_f32 v[82:83], v[82:83], v[86:87]
    v_add_f32 v73, v73, v75
    v_mov_b32 v75, v73
    v_permlane16_swap_b32 v80, v82
    v_permlane16_swap_b32 v81, v83
    v_permlane16_swap_b32 v73, v75
    v_pk_add_f32 v[80:81], v[80:81], v[82:83]
    v_add_f32 v73, v73, v75
    ds_write_b64 v232, v[80:81] offset:12288
    ds_write_b64 v233, v[72:73] offset:64
    v_and_b32 v76, 7, v0
    v_lshlrev_b32 v76, 3, v76
    v_lshlrev_b32 v77, 3, v2
    s_waitcnt lgkmcnt(0)
    s_barrier
    s_cmp_lg_u32 s4, 0
    s_cbranch_scc1 L_role
    ds_read_b64 v[80:81], v76 offset:64
    ds_read_b64 v[82:83], v77 offset:12288
    ds_read_b64 v[84:85], v77 offset:12800
    ds_read_b64 v[86:87], v77 offset:13312
    ds_read_b64 v[88:89], v77 offset:13824
    ds_read_b64 v[90:91], v77 offset:14336
    ds_read_b64 v[92:93], v77 offset:14848
    ds_read_b64 v[94:95], v77 offset:15360
    ds_read_b64 v[96:97], v77 offset:15872
    s_lshl_b32 s3, s26, 9
    s_add_u32 s3, s3, 0x10000
    s_lshl_b32 s7, s26, 7
    s_add_u32 s7, s7, 0x38000
    s_waitcnt lgkmcnt(0)
    v_max_f32_dpp v72, v80, v80 quad_perm:[1,0,3,2] row_mask:0xf bank_mask:0xf
    s_nop 1
    v_max_f32_dpp v72, v72, v72 quad_perm:[2,3,0,1] row_mask:0xf bank_mask:0xf
    s_nop 1
    v_max_f32_dpp v72, v72, v72 row_half_mirror row_mask:0xf bank_mask:0xf
    v_sub_f32 v78, v80, v72
    v_mul_f32 v78, s88, v78
    v_exp_f32 v78, v78
    s_nop 0
    v_mul_f32 v73, v78, v81
    v_readlane_b32 s76, v78, 0
    v_readlane_b32 s77, v78, 1
    v_add_f32_dpp v73, v73, v73 quad_perm:[1,0,3,2] row_mask:0xf bank_mask:0xf
    v_readlane_b32 s78, v78, 2
    v_readlane_b32 s79, v78, 3
    v_readlane_b32 s80, v78, 4
    v_add_f32_dpp v73, v73, v73 quad_perm:[2,3,0,1] row_mask:0xf bank_mask:0xf
    v_readlane_b32 s81, v78, 5
    v_readlane_b32 s82, v78, 6
    v_readlane_b32 s83, v78, 7
    v_add_f32_dpp v73, v73, v73 row_half_mirror row_mask:0xf bank_mask:0xf
    v_pk_mul_f32 v[100:101], v[82:83], s[76:77] op_sel_hi:[1,0]
    v_pk_fma_f32 v[100:101], v[84:85], s[76:77], v[100:101] op_sel:[0,1,0] op_sel_hi:[1,1,1]
    v_pk_fma_f32 v[100:101], v[86:87], s[78:79], v[100:101] op_sel_hi:[1,0,1]
    v_pk_fma_f32 v[100:101], v[88:89], s[78:79], v[100:101] op_sel:[0,1,0] op_sel_hi:[1,1,1]
    v_pk_fma_f32 v[100:101], v[90:91], s[80:81], v[100:101] op_sel_hi:[1,0,1]
    v_pk_fma_f32 v[100:101], v[92:93], s[80:81], v[100:101] op_sel:[0,1,0] op_sel_hi:[1,1,1]
    v_pk_fma_f32 v[100:101], v[94:95], s[82:83], v[100:101] op_sel_hi:[1,0,1]
    v_pk_fma_f32 v[100:101], v[96:97], s[82:83], v[100:101] op_sel:[0,1,0] op_sel_hi:[1,1,1]
    s_nop 1
    v_mov_b32_dpp v102, v100 quad_perm:[1,1,3,3] row_mask:0xf bank_mask:0xf
    v_mov_b32_dpp v103, v101 quad_perm:[1,1,3,3] row_mask:0xf bank_mask:0xf
    s_mov_b32 exec_lo, 0x55555555
    s_mov_b32 exec_hi, 0x55555555
    buffer_store_dwordx4 v[100:103], v77, s[44:47], s3 offen sc1
    s_mov_b64 exec, 1
    buffer_store_dwordx2 v[72:73], v77, s[44:47], s7 offen sc1
    s_mov_b64 exec, -1
L_role:
    s_nop 4
    s_cmp_lg_u32 s90, 3
    s_cbranch_scc1 L_end
    v_and_b32 v72, 7, v0
    v_lshrrev_b32 v73, 4, v0
    v_lshlrev_b32 v74, 3, v72
    v_lshl_add_u32 v15, v73, 6, v74
    v_and_b32 v77, 8, v0
    v_and_b32 v8, 0xff, v15
    v_lshl_add_u32 v8, v77, 8, v8
    v_and_b32 v9, 3, v0
    v_lshlrev_b32 v9, 7, v9
    v_lshl_add_u32 v9, v77, 6, v9
    s_lshr_b32 s97, s91, 2
    s_lshl_b32 s3, s97, 2
    s_lshr_b32 s7, s4, 1
    s_add_u32 s7, s7, s3
    s_lshl_b32 s3, s7, 12
    s_and_b32 s84, s4, 1
    s_lshl_b32 s84, s84, 8
    s_add_u32 s3, s3, s84
    s_add_u32 s3, s3, 0x10000
    s_lshl_b32 s7, s7, 10
    s_add_u32 s7, s7, 0x38000
    buffer_load_dwordx2 v[22:23], v9, s[44:47], s7 offen sc1
    buffer_load_dwordx2 v[24:25], v8, s[44:47], s3 offen offset:0 sc1
    buffer_load_dwordx2 v[26:27], v8, s[44:47], s3 offen offset:512 sc1
    buffer_load_dwordx2 v[28:29], v8, s[44:47], s3 offen offset:1024 sc1
    buffer_load_dwordx2 v[30:31], v8, s[44:47], s3 offen offset:1536 sc1
    v_lshlrev_b32 v14, 2, v0
    v_and_b32 v75, 15, v0
    v_lshlrev_b32 v21, 2, v75
    s_mov_b32 s76, 0x1000
    s_mov_b32 s77, 0x2000
    s_lshl_b32 s84, s91, 6
    s_add_u32 s85, s84, 0x2800
    buffer_load_dword v240, v14, s[44:47], s76 offen sc1
    buffer_load_dwordx2 v[242:243], v15, s[44:47], s76 offen offset:2048 sc1
    buffer_load_dwordx2 v[244:245], v15, s[44:47], s77 offen sc1
    buffer_load_dword v246, v21, s[44:47], s85 offen sc1
    v_add_u32 v6, s84, v21
    v_lshlrev_b32 v5, 1, v75
    s_and_b32 s85, s91, 3
    s_lshl_b32 s85, s85, 12
    s_lshl_b32 s84, s97, 8
    s_add_u32 s85, s85, s84
    s_add_u32 s85, s85, 0x4000
    v_bfe_u32 v76, v0, 4, 2
    v_lshlrev_b32 v76, 3, v76
    v_lshl_add_u32 v10, v75, 5, v76
    v_lshl_add_u32 v10, v233, 6, v10
    v_lshlrev_b32 v11, 3, v2
    v_and_b32 v12, 0xff, v11
    v_and_b32 v77, 32, v0
    v_lshl_add_u32 v12, v77, 6, v12
    v_lshl_add_u32 v13, v233, 6, v2
    v_lshlrev_b32 v13, 2, v13
    v_lshlrev_b32 v16, 5, v2
    v_lshlrev_b32 v17, 2, v2
    v_add_u32 v17, 0x2000, v17
    v_lshlrev_b32 v18, 1, v2
    v_lshrrev_b32 v19, 1, v0
    v_lshlrev_b32 v19, 4, v19
    v_and_b32 v20, 1, v0
    v_lshl_add_u32 v20, v20, 5, v76
    v_lshl_add_u32 v20, v233, 3, v20
    v_lshlrev_b32 v241, 16, v3
    s_branch L_pBw
L_pB:
    buffer_load_dwordx2 v[22:23], v9, s[44:47], s7 offen sc1
    buffer_load_dwordx2 v[24:25], v8, s[44:47], s3 offen offset:0 sc1
    buffer_load_dwordx2 v[26:27], v8, s[44:47], s3 offen offset:512 sc1
    buffer_load_dwordx2 v[28:29], v8, s[44:47], s3 offen offset:1024 sc1
    buffer_load_dwordx2 v[30:31], v8, s[44:47], s3 offen offset:1536 sc1
L_pBw:
    s_waitcnt vmcnt(0)
    v_max_u32 v74, v22, v23
    v_max3_u32 v74, v74, v24, v25
    v_max3_u32 v74, v74, v26, v27
    v_max3_u32 v74, v74, v28, v29
    v_max3_u32 v74, v74, v30, v31
    v_cmp_eq_u32 vcc, -1, v74
    s_cbranch_vccz L_pB_ok
    s_add_u32 s94, s94, 1
    s_cmp_lt_u32 s94, 0x40000
    s_cbranch_scc1 L_pB
    s_branch L_end
L_pB_ok:
    s_nop 4
    v_max_f32_dpp v75, v22, v22 quad_perm:[1,0,3,2] row_mask:0xf bank_mask:0xf
    s_nop 1
    v_max_f32_dpp v75, v75, v75 quad_perm:[2,3,0,1] row_mask:0xf bank_mask:0xf
    s_nop 1
    v_max_f32_dpp v75, v75, v75 row_ror:8 row_mask:0xf bank_mask:0xf
    v_sub_f32 v78, v22, v75
    v_mul_f32 v78, s88, v78
    v_exp_f32 v78, v78
    s_nop 0
    v_mul_f32 v74, v78, v23
    v_mul_f32_dpp v76, v78, v24 quad_perm:[0,0,0,0] row_mask:0xf bank_mask:0xf
    v_mul_f32_dpp v77, v78, v25 quad_perm:[0,0,0,0] row_mask:0xf bank_mask:0xf
    v_add_f32_dpp v74, v74, v74 quad_perm:[1,0,3,2] row_mask:0xf bank_mask:0xf
    v_fmac_f32_dpp v76, v78, v26 quad_perm:[1,1,1,1] row_mask:0xf bank_mask:0xf
    v_fmac_f32_dpp v77, v78, v27 quad_perm:[1,1,1,1] row_mask:0xf bank_mask:0xf
    v_add_f32_dpp v74, v74, v74 quad_perm:[2,3,0,1] row_mask:0xf bank_mask:0xf
    v_fmac_f32_dpp v76, v78, v28 quad_perm:[2,2,2,2] row_mask:0xf bank_mask:0xf
    v_fmac_f32_dpp v77, v78, v29 quad_perm:[2,2,2,2] row_mask:0xf bank_mask:0xf
    v_add_f32_dpp v74, v74, v74 row_ror:8 row_mask:0xf bank_mask:0xf
    v_fmac_f32_dpp v76, v78, v30 quad_perm:[3,3,3,3] row_mask:0xf bank_mask:0xf
    v_fmac_f32_dpp v77, v78, v31 quad_perm:[3,3,3,3] row_mask:0xf bank_mask:0xf
    v_rcp_f32 v74, v74
    v_add_f32_dpp v76, v76, v76 row_ror:8 row_mask:0xf bank_mask:0xf
    v_add_f32_dpp v77, v77, v77 row_ror:8 row_mask:0xf bank_mask:0xf
    v_pk_mul_f32 v[76:77], v[76:77], v[74:75] op_sel_hi:[1,0]
    v_cvt_pk_bf16_f32 v76, v76, v77
    s_nop 1
    v_mov_b32_dpp v80, v76 row_newbcast:0 row_mask:0xf bank_mask:0xf
    v_mov_b32_dpp v81, v76 row_newbcast:1 row_mask:0xf bank_mask:0xf
    v_mov_b32_dpp v82, v76 row_newbcast:2 row_mask:0xf bank_mask:0xf
    v_mov_b32_dpp v83, v76 row_newbcast:3 row_mask:0xf bank_mask:0xf
    v_mov_b32_dpp v84, v76 row_newbcast:4 row_mask:0xf bank_mask:0xf
    v_mov_b32_dpp v85, v76 row_newbcast:5 row_mask:0xf bank_mask:0xf
    v_mov_b32_dpp v86, v76 row_newbcast:6 row_mask:0xf bank_mask:0xf
    v_mov_b32_dpp v87, v76 row_newbcast:7 row_mask:0xf bank_mask:0xf
    v_dot2_f32_bf16 v88, v234, v80, 0
    v_dot2_f32_bf16 v89, v108, v80, 0
    v_dot2_f32_bf16 v90, v104, v80, 0
    v_dot2_f32_bf16 v91, v109, v80, 0
    v_dot2_f32_bf16 v92, v105, v80, 0
    v_dot2_f32_bf16 v93, v110, v80, 0
    v_dot2_f32_bf16 v94, v106, v80, 0
    v_dot2_f32_bf16 v95, v111, v80, 0
    v_dot2_f32_bf16 v88, v107, v81, v88
    v_dot2_f32_bf16 v89, v116, v81, v89
    v_dot2_f32_bf16 v90, v112, v81, v90
    v_dot2_f32_bf16 v91, v117, v81, v91
    v_dot2_f32_bf16 v92, v113, v81, v92
    v_dot2_f32_bf16 v93, v118, v81, v93
    v_dot2_f32_bf16 v94, v114, v81, v94
    v_dot2_f32_bf16 v95, v119, v81, v95
    v_dot2_f32_bf16 v88, v115, v82, v88
    v_dot2_f32_bf16 v89, v124, v82, v89
    v_dot2_f32_bf16 v90, v120, v82, v90
    v_dot2_f32_bf16 v91, v125, v82, v91
    v_dot2_f32_bf16 v92, v121, v82, v92
    v_dot2_f32_bf16 v93, v126, v82, v93
    v_dot2_f32_bf16 v94, v122, v82, v94
    v_dot2_f32_bf16 v95, v127, v82, v95
    v_dot2_f32_bf16 v88, v123, v83, v88
    v_dot2_f32_bf16 v89, v132, v83, v89
    v_dot2_f32_bf16 v90, v128, v83, v90
    v_dot2_f32_bf16 v91, v133, v83, v91
    v_dot2_f32_bf16 v92, v129, v83, v92
    v_dot2_f32_bf16 v93, v134, v83, v93
    v_dot2_f32_bf16 v94, v130, v83, v94
    v_dot2_f32_bf16 v95, v135, v83, v95
    v_dot2_f32_bf16 v88, v131, v84, v88
    v_dot2_f32_bf16 v89, v140, v84, v89
    v_dot2_f32_bf16 v90, v136, v84, v90
    v_dot2_f32_bf16 v91, v141, v84, v91
    v_dot2_f32_bf16 v92, v137, v84, v92
    v_dot2_f32_bf16 v93, v142, v84, v93
    v_dot2_f32_bf16 v94, v138, v84, v94
    v_dot2_f32_bf16 v95, v143, v84, v95
    v_dot2_f32_bf16 v88, v139, v85, v88
    v_dot2_f32_bf16 v89, v148, v85, v89
    v_dot2_f32_bf16 v90, v144, v85, v90
    v_dot2_f32_bf16 v91, v149, v85, v91
    v_dot2_f32_bf16 v92, v145, v85, v92
    v_dot2_f32_bf16 v93, v150, v85, v93
    v_dot2_f32_bf16 v94, v146, v85, v94
    v_dot2_f32_bf16 v95, v151, v85, v95
    v_dot2_f32_bf16 v88, v147, v86, v88
    v_dot2_f32_bf16 v89, v156, v86, v89
    v_dot2_f32_bf16 v90, v152, v86, v90
    v_dot2_f32_bf16 v91, v157, v86, v91
    v_dot2_f32_bf16 v92, v153, v86, v92
    v_dot2_f32_bf16 v93, v158, v86, v93
    v_dot2_f32_bf16 v94, v154, v86, v94
    v_dot2_f32_bf16 v95, v159, v86, v95
    v_dot2_f32_bf16 v88, v155, v87, v88
    v_dot2_f32_bf16 v89, v164, v87, v89
    v_dot2_f32_bf16 v90, v160, v87, v90
    v_dot2_f32_bf16 v91, v165, v87, v91
    v_dot2_f32_bf16 v92, v161, v87, v92
    v_dot2_f32_bf16 v93, v166, v87, v93
    v_dot2_f32_bf16 v94, v162, v87, v94
    v_dot2_f32_bf16 v95, v167, v87, v95
    v_permlane32_swap_b32 v88, v92
    v_permlane32_swap_b32 v89, v93
    v_permlane32_swap_b32 v90, v94
    v_permlane32_swap_b32 v91, v95
    v_pk_add_f32 v[88:89], v[88:89], v[92:93]
    v_pk_add_f32 v[90:91], v[90:91], v[94:95]
    s_nop 1
    v_permlane16_swap_b32 v88, v90
    v_permlane16_swap_b32 v89, v91
    v_pk_add_f32 v[88:89], v[88:89], v[90:91]
    ds_write_b64 v10, v[88:89] offset:8192
    s_mov_b32 s3, 0x4000
    s_waitcnt lgkmcnt(0)
    s_barrier
    s_cmp_lg_u32 s4, 0
    s_cbranch_scc1 L_C0
    ds_read_b64 v[80:81], v11 offset:8192
    ds_read_b64 v[82:83], v11 offset:8704
    ds_read_b64 v[84:85], v11 offset:9216
    ds_read_b64 v[86:87], v11 offset:9728
    ds_read_b64 v[88:89], v11 offset:10240
    ds_read_b64 v[90:91], v11 offset:10752
    ds_read_b64 v[92:93], v11 offset:11264
    ds_read_b64 v[94:95], v11 offset:11776
    s_cmp_eq_u32 s0, 0
    s_waitcnt lgkmcnt(0)
    v_pk_add_f32 v[80:81], v[80:81], v[88:89]
    v_pk_add_f32 v[82:83], v[82:83], v[90:91]
    v_pk_add_f32 v[84:85], v[84:85], v[92:93]
    v_pk_add_f32 v[86:87], v[86:87], v[94:95]
    v_pk_add_f32 v[80:81], v[80:81], v[84:85]
    v_pk_add_f32 v[82:83], v[82:83], v[86:87]
    v_pk_add_f32 v[80:81], v[80:81], v[82:83]
    s_nop 1
    v_mov_b32_dpp v82, v80 quad_perm:[1,1,3,3] row_mask:0xf bank_mask:0xf
    v_mov_b32_dpp v83, v81 quad_perm:[1,1,3,3] row_mask:0xf bank_mask:0xf
    s_mov_b32 exec_lo, 0x55555555
    s_mov_b32 exec_hi, 0x55555555
    s_cbranch_scc1 L_sB_s
    buffer_store_dwordx4 v[80:83], v12, s[44:47], s85 offen
L_sB_j:
    s_mov_b64 exec, -1
L_C0:
    v_add_f32 v244, 1.0, v244
    v_cvt_pk_bf16_f32 v244, 0, v244
    v_add_f32 v245, 1.0, v245
    v_cvt_pk_bf16_f32 v245, 0, v245
L_pC:
    s_nop 4
    buffer_load_dword v22, v13, s[44:47], s3 offen offset:0 sc1
    buffer_load_dword v23, v13, s[44:47], s3 offen offset:256 sc1
    buffer_load_dword v24, v13, s[44:47], s3 offen offset:512 sc1
    buffer_load_dword v25, v13, s[44:47], s3 offen offset:768 sc1
    buffer_load_dword v26, v13, s[44:47], s3 offen offset:1024 sc1
    buffer_load_dword v27, v13, s[44:47], s3 offen offset:1280 sc1
    buffer_load_dword v28, v13, s[44:47], s3 offen offset:1536 sc1
    buffer_load_dword v29, v13, s[44:47], s3 offen offset:1792 sc1
    s_waitcnt vmcnt(0)
    v_max_u32 v74, v22, v23
    v_max3_u32 v74, v74, v24, v25
    v_max3_u32 v74, v74, v26, v27
    v_max3_u32 v74, v74, v28, v29
    v_cmp_eq_u32 vcc, -1, v74
    s_cbranch_vccz L_pC_ok
    s_add_u32 s94, s94, 1
    s_cmp_lt_u32 s94, 0x40000
    s_cbranch_scc1 L_pC
    s_branch L_end
L_pC_ok:
    s_nop 4
    v_pk_add_f32 v[74:75], v[22:23], v[26:27]
    v_pk_add_f32 v[76:77], v[24:25], v[28:29]
    v_pk_add_f32 v[74:75], v[74:75], v[76:77]
    v_add_f32 v74, v74, v75
    v_cvt_pk_bf16_f32 v74, 0, v74
    v_mul_f32 v74, v240, v74
    v_cvt_pk_bf16_f32 v74, 0, v74
    v_add_f32 v241, v241, v74
    v_cvt_pk_bf16_f32 v241, 0, v241
    ds_write_b32 v14, v241 offset:4096
    s_lshl_b32 s85, s91, 7
    s_add_u32 s85, s85, 0x8000
    s_mov_b32 s3, 0x8000
    s_cmp_ge_u32 s91, 28
    s_waitcnt lgkmcnt(0)
    s_barrier
    s_cbranch_scc1 L_phD
    ds_read_b128 v[80:83], v16 offset:4096
    ds_read_b128 v[84:87], v16 offset:4112
    ds_read_b64 v[74:75], v15 offset:4096
    s_waitcnt lgkmcnt(0)
    v_readfirstlane_b32 s76, v80
    s_mov_b32 s84, 0x3b000000
    s_nop 0
    v_pk_add_f32 v[80:81], v[80:81], s[76:77] op_sel_hi:[1,0] neg_lo:[0,1] neg_hi:[0,1]
    v_pk_add_f32 v[82:83], v[82:83], s[76:77] op_sel_hi:[1,0] neg_lo:[0,1] neg_hi:[0,1]
    v_pk_add_f32 v[84:85], v[84:85], s[76:77] op_sel_hi:[1,0] neg_lo:[0,1] neg_hi:[0,1]
    v_pk_add_f32 v[86:87], v[86:87], s[76:77] op_sel_hi:[1,0] neg_lo:[0,1] neg_hi:[0,1]
    v_pk_mul_f32 v[94:95], v[80:81], v[80:81]
    v_pk_fma_f32 v[94:95], v[82:83], v[82:83], v[94:95]
    v_pk_fma_f32 v[94:95], v[84:85], v[84:85], v[94:95]
    v_pk_fma_f32 v[94:95], v[86:87], v[86:87], v[94:95]
    v_pk_add_f32 v[80:81], v[80:81], v[82:83]
    v_pk_add_f32 v[84:85], v[84:85], v[86:87]
    v_add_f32 v90, v94, v95
    v_pk_add_f32 v[80:81], v[80:81], v[84:85]
    v_add_f32 v88, v80, v81
    s_nop 1
    v_add_f32_dpp v88, v88, v88 row_ror:8 row_mask:0xf bank_mask:0xf
    v_add_f32_dpp v90, v90, v90 row_ror:8 row_mask:0xf bank_mask:0xf
    s_nop 0
    v_add_f32_dpp v88, v88, v88 row_ror:4 row_mask:0xf bank_mask:0xf
    v_add_f32_dpp v90, v90, v90 row_ror:4 row_mask:0xf bank_mask:0xf
    s_nop 0
    v_add_f32_dpp v88, v88, v88 row_ror:2 row_mask:0xf bank_mask:0xf
    v_add_f32_dpp v90, v90, v90 row_ror:2 row_mask:0xf bank_mask:0xf
    s_nop 0
    v_add_f32_dpp v88, v88, v88 row_ror:1 row_mask:0xf bank_mask:0xf
    v_add_f32_dpp v90, v90, v90 row_ror:1 row_mask:0xf bank_mask:0xf
    s_nop 1
    v_permlane32_swap_b32 v88, v90
    v_add_f32 v88, v88, v90
    v_mov_b32 v90, v88
    s_nop 1
    v_permlane16_swap_b32 v88, v90
    v_add_f32 v88, v88, v90
    v_mov_b32 v90, v88
    s_nop 1
    v_permlane32_swap_b32 v88, v90
    v_mul_f32 v88, 0x3b000000, v88
    v_mul_f32 v94, v88, v88
    v_add_f32 v88, s76, v88
    v_fma_f32 v90, v90, s84, -v94
    v_max_f32 v90, 0, v90
    v_cvt_pk_bf16_f32 v90, 0, v90
    v_add_f32 v90, 0x3727c5ac, v90
    v_cvt_pk_bf16_f32 v90, 0, v90
    v_sqrt_f32 v90, v90
    s_nop 0
    v_cvt_pk_bf16_f32 v90, 0, v90
    v_rcp_f32 v92, v90
    v_cvt_pk_bf16_f32 v88, 0, v88
    v_pk_add_f32 v[74:75], v[74:75], v[88:89] op_sel_hi:[1,0] neg_lo:[0,1] neg_hi:[0,1]
    v_cvt_pk_bf16_f32 v74, 0, v74
    v_cvt_pk_bf16_f32 v75, 0, v75
    v_pk_mul_f32 v[76:77], v[74:75], v[92:93] op_sel_hi:[1,0]
    v_pk_fma_f32 v[78:79], v[76:77], v[90:91], v[74:75] op_sel_hi:[1,0,1] neg_lo:[1,0,0] neg_hi:[1,0,0]
    v_pk_fma_f32 v[76:77], v[78:79], v[92:93], v[76:77] op_sel_hi:[1,0,1]
    v_cvt_pk_bf16_f32 v76, 0, v76
    v_cvt_pk_bf16_f32 v77, 0, v77
    v_pk_mul_f32 v[76:77], v[76:77], v[244:245]
    v_cvt_pk_bf16_f32 v76, 0, v76
    v_cvt_pk_bf16_f32 v77, 0, v77
    v_pk_add_f32 v[76:77], v[76:77], v[242:243]
    v_cvt_pk_bf16_f32 v76, v76, v77
    s_nop 1
    v_mov_b32_dpp v80, v76 row_newbcast:0 row_mask:0xf bank_mask:0xf
    v_mov_b32_dpp v81, v76 row_newbcast:1 row_mask:0xf bank_mask:0xf
    v_mov_b32_dpp v82, v76 row_newbcast:2 row_mask:0xf bank_mask:0xf
    v_mov_b32_dpp v83, v76 row_newbcast:3 row_mask:0xf bank_mask:0xf
    v_mov_b32_dpp v84, v76 row_newbcast:4 row_mask:0xf bank_mask:0xf
    v_mov_b32_dpp v85, v76 row_newbcast:5 row_mask:0xf bank_mask:0xf
    v_mov_b32_dpp v86, v76 row_newbcast:6 row_mask:0xf bank_mask:0xf
    v_mov_b32_dpp v87, v76 row_newbcast:7 row_mask:0xf bank_mask:0xf
    v_dot2_f32_bf16 v88, v163, v80, 0
    v_dot2_f32_bf16 v89, v172, v80, 0
    v_dot2_f32_bf16 v90, v168, v80, 0
    v_dot2_f32_bf16 v91, v173, v80, 0
    v_dot2_f32_bf16 v92, v169, v80, 0
    v_dot2_f32_bf16 v93, v174, v80, 0
    v_dot2_f32_bf16 v94, v170, v80, 0
    v_dot2_f32_bf16 v95, v175, v80, 0
    v_dot2_f32_bf16 v88, v171, v81, v88
    v_dot2_f32_bf16 v89, v180, v81, v89
    v_dot2_f32_bf16 v90, v176, v81, v90
    v_dot2_f32_bf16 v91, v181, v81, v91
    v_dot2_f32_bf16 v92, v177, v81, v92
    v_dot2_f32_bf16 v93, v182, v81, v93
    v_dot2_f32_bf16 v94, v178, v81, v94
    v_dot2_f32_bf16 v95, v183, v81, v95
    v_dot2_f32_bf16 v88, v179, v82, v88
    v_dot2_f32_bf16 v89, v188, v82, v89
    v_dot2_f32_bf16 v90, v184, v82, v90
    v_dot2_f32_bf16 v91, v189, v82, v91
    v_dot2_f32_bf16 v92, v185, v82, v92
    v_dot2_f32_bf16 v93, v190, v82, v93
    v_dot2_f32_bf16 v94, v186, v82, v94
    v_dot2_f32_bf16 v95, v191, v82, v95
    v_dot2_f32_bf16 v88, v187, v83, v88
    v_dot2_f32_bf16 v89, v196, v83, v89
    v_dot2_f32_bf16 v90, v192, v83, v90
    v_dot2_f32_bf16 v91, v197, v83, v91
    v_dot2_f32_bf16 v92, v193, v83, v92
    v_dot2_f32_bf16 v93, v198, v83, v93
    v_dot2_f32_bf16 v94, v194, v83, v94
    v_dot2_f32_bf16 v95, v199, v83, v95
    v_dot2_f32_bf16 v88, v195, v84, v88
    v_dot2_f32_bf16 v89, v204, v84, v89
    v_dot2_f32_bf16 v90, v200, v84, v90
    v_dot2_f32_bf16 v91, v205, v84, v91
    v_dot2_f32_bf16 v92, v201, v84, v92
    v_dot2_f32_bf16 v93, v206, v84, v93
    v_dot2_f32_bf16 v94, v202, v84, v94
    v_dot2_f32_bf16 v95, v207, v84, v95
    v_dot2_f32_bf16 v88, v203, v85, v88
    v_dot2_f32_bf16 v89, v212, v85, v89
    v_dot2_f32_bf16 v90, v208, v85, v90
    v_dot2_f32_bf16 v91, v213, v85, v91
    v_dot2_f32_bf16 v92, v209, v85, v92
    v_dot2_f32_bf16 v93, v214, v85, v93
    v_dot2_f32_bf16 v94, v210, v85, v94
    v_dot2_f32_bf16 v95, v215, v85, v95
    v_dot2_f32_bf16 v88, v211, v86, v88
    v_dot2_f32_bf16 v89, v220, v86, v89
    v_dot2_f32_bf16 v90, v216, v86, v90
    v_dot2_f32_bf16 v91, v221, v86, v91
    v_dot2_f32_bf16 v92, v217, v86, v92
    v_dot2_f32_bf16 v93, v222, v86, v93
    v_dot2_f32_bf16 v94, v218, v86, v94
    v_dot2_f32_bf16 v95, v223, v86, v95
    v_dot2_f32_bf16 v88, v219, v87, v88
    v_dot2_f32_bf16 v89, v228, v87, v89
    v_dot2_f32_bf16 v90, v224, v87, v90
    v_dot2_f32_bf16 v91, v229, v87, v91
    v_dot2_f32_bf16 v92, v225, v87, v92
    v_dot2_f32_bf16 v93, v230, v87, v93
    v_dot2_f32_bf16 v94, v226, v87, v94
    v_dot2_f32_bf16 v95, v231, v87, v95
    v_permlane32_swap_b32 v88, v92
    v_permlane32_swap_b32 v89, v93
    v_permlane32_swap_b32 v90, v94
    v_permlane32_swap_b32 v91, v95
    v_pk_add_f32 v[88:89], v[88:89], v[92:93]
    v_pk_add_f32 v[90:91], v[90:91], v[94:95]
    s_nop 1
    v_permlane16_swap_b32 v88, v90
    v_permlane16_swap_b32 v89, v91
    v_pk_add_f32 v[88:89], v[88:89], v[90:91]
    ds_write_b64 v10, v[88:89] offset:8192
    s_waitcnt lgkmcnt(0)
    s_barrier
    s_cmp_lg_u32 s4, 0
    s_cbranch_scc1 L_phD
    ds_read2st64_b32 v[80:81], v17 offset0:0 offset1:1
    ds_read2st64_b32 v[82:83], v17 offset0:2 offset1:3
    ds_read2st64_b32 v[84:85], v17 offset0:4 offset1:5
    ds_read2st64_b32 v[86:87], v17 offset0:6 offset1:7
    ds_read2st64_b32 v[88:89], v17 offset0:8 offset1:9
    ds_read2st64_b32 v[90:91], v17 offset0:10 offset1:11
    ds_read2st64_b32 v[92:93], v17 offset0:12 offset1:13
    ds_read2st64_b32 v[94:95], v17 offset0:14 offset1:15
    s_cmp_eq_u32 s0, 0
    s_waitcnt lgkmcnt(0)
    v_pk_add_f32 v[80:81], v[80:81], v[88:89]
    v_pk_add_f32 v[82:83], v[82:83], v[90:91]
    v_pk_add_f32 v[84:85], v[84:85], v[92:93]
    v_pk_add_f32 v[86:87], v[86:87], v[94:95]
    v_pk_add_f32 v[80:81], v[80:81], v[84:85]
    v_pk_add_f32 v[82:83], v[82:83], v[86:87]
    v_pk_add_f32 v[80:81], v[80:81], v[82:83]
    v_cvt_pk_bf16_f32 v80, 0, v80
    v_cvt_pk_bf16_f32 v81, 0, v81
    v_mul_f32 v76, s88, v80
    v_exp_f32 v76, -v76
    s_nop 0
    v_min_f32 v76, 0x7f000000, v76
    v_add_f32 v76, 1.0, v76
    v_rcp_f32 v77, v76
    s_nop 0
    v_mul_f32 v75, v80, v77
    v_fma_f32 v78, -v75, v76, v80
    v_fmac_f32 v75, v78, v77
    v_cvt_pk_bf16_f32 v75, 0, v75
    v_mul_f32 v75, v75, v81
    s_nop 1
    v_mov_b32_dpp v74, v75 quad_perm:[1,1,3,3] row_mask:0xf bank_mask:0xf
    v_cvt_pk_bf16_f32 v76, v75, v74
    s_nop 1
    v_mov_b32_dpp v77, v76 row_shl:2 row_mask:0xf bank_mask:0xf
    v_mov_b32_dpp v78, v76 row_shl:4 row_mask:0xf bank_mask:0xf
    v_mov_b32_dpp v79, v76 row_shl:6 row_mask:0xf bank_mask:0xf
    s_mov_b32 exec_lo, 0x1010101
    s_mov_b32 exec_hi, 0x1010101
    s_cbranch_scc1 L_sC_s
    buffer_store_dwordx4 v[76:79], v18, s[44:47], s85 offen
L_sC_j:
    s_mov_b64 exec, -1
L_phD:
    s_nop 4
    s_cmp_eq_u32 s4, 7
    s_cbranch_scc1 L_end
    ds_read_b32 v247, v6 offset:4096
    s_lshl_b32 s85, s91, 5
L_pD:
    s_nop 4
    buffer_load_dwordx4 v[24:27], v19, s[44:47], s3 offen sc1
    s_waitcnt vmcnt(0)
    v_max_u32 v74, v24, v25
    v_max3_u32 v74, v74, v26, v27
    v_cmp_eq_u32 vcc, -1, v74
    s_cbranch_vccz L_pD_ok
    s_add_u32 s94, s94, 1
    s_cmp_lt_u32 s94, 0x40000
    s_cbranch_scc1 L_pD
    s_branch L_end
L_pD_ok:
    s_nop 4
    v_dot2_f32_bf16 v88, v227, v24, 0
    v_dot2_f32_bf16 v89, v44, v24, 0
    v_dot2_f32_bf16 v90, v40, v24, 0
    v_dot2_f32_bf16 v91, v45, v24, 0
    v_dot2_f32_bf16 v92, v41, v24, 0
    v_dot2_f32_bf16 v93, v46, v24, 0
    v_dot2_f32_bf16 v94, v42, v24, 0
    v_dot2_f32_bf16 v95, v47, v24, 0
    v_dot2_f32_bf16 v88, v43, v25, v88
    v_dot2_f32_bf16 v89, v52, v25, v89
    v_dot2_f32_bf16 v90, v48, v25, v90
    v_dot2_f32_bf16 v91, v53, v25, v91
    v_dot2_f32_bf16 v92, v49, v25, v92
    v_dot2_f32_bf16 v93, v54, v25, v93
    v_dot2_f32_bf16 v94, v50, v25, v94
    v_dot2_f32_bf16 v95, v55, v25, v95
    v_dot2_f32_bf16 v88, v51, v26, v88
    v_dot2_f32_bf16 v89, v60, v26, v89
    v_dot2_f32_bf16 v90, v56, v26, v90
    v_dot2_f32_bf16 v91, v61, v26, v91
    v_dot2_f32_bf16 v92, v57, v26, v92
    v_dot2_f32_bf16 v93, v62, v26, v93
    v_dot2_f32_bf16 v94, v58, v26, v94
    v_dot2_f32_bf16 v95, v63, v26, v95
    v_dot2_f32_bf16 v88, v59, v27, v88
    v_dot2_f32_bf16 v89, v68, v27, v89
    v_dot2_f32_bf16 v90, v64, v27, v90
    v_dot2_f32_bf16 v91, v69, v27, v91
    v_dot2_f32_bf16 v92, v65, v27, v92
    v_dot2_f32_bf16 v93, v70, v27, v93
    v_dot2_f32_bf16 v94, v66, v27, v94
    v_dot2_f32_bf16 v95, v71, v27, v95
    v_permlane32_swap_b32 v88, v92
    v_permlane32_swap_b32 v89, v93
    v_permlane32_swap_b32 v90, v94
    v_permlane32_swap_b32 v91, v95
    v_pk_add_f32 v[88:89], v[88:89], v[92:93]
    v_pk_add_f32 v[90:91], v[90:91], v[94:95]
    s_nop 1
    v_permlane16_swap_b32 v88, v90
    v_permlane16_swap_b32 v89, v91
    v_pk_add_f32 v[88:89], v[88:89], v[90:91]
    s_nop 1
    v_add_f32_dpp v88, v88, v88 row_ror:8 row_mask:0xf bank_mask:0xf
    v_add_f32_dpp v89, v89, v89 row_ror:8 row_mask:0xf bank_mask:0xf
    s_nop 0
    v_add_f32_dpp v88, v88, v88 row_ror:4 row_mask:0xf bank_mask:0xf
    v_add_f32_dpp v89, v89, v89 row_ror:4 row_mask:0xf bank_mask:0xf
    s_nop 0
    v_add_f32_dpp v88, v88, v88 row_ror:2 row_mask:0xf bank_mask:0xf
    v_add_f32_dpp v89, v89, v89 row_ror:2 row_mask:0xf bank_mask:0xf
    ds_write_b64 v20, v[88:89] offset:6144
    s_waitcnt lgkmcnt(0)
    s_barrier
    s_cmp_lg_u32 s4, 0
    s_cbranch_scc1 L_end
    ds_read_b32 v80, v21 offset:6144
    ds_read_b32 v81, v21 offset:6208
    ds_read_b32 v82, v21 offset:6272
    ds_read_b32 v83, v21 offset:6336
    ds_read_b32 v84, v21 offset:6400
    ds_read_b32 v85, v21 offset:6464
    ds_read_b32 v86, v21 offset:6528
    v_mov_b32 v87, 0
    s_waitcnt lgkmcnt(0)
    v_pk_add_f32 v[80:81], v[80:81], v[84:85]
    v_pk_add_f32 v[82:83], v[82:83], v[86:87]
    v_pk_add_f32 v[80:81], v[80:81], v[82:83]
    v_add_f32 v72, v80, v81
    v_cvt_pk_bf16_f32 v72, 0, v72
    v_mul_f32 v72, v246, v72
    v_cvt_pk_bf16_f32 v72, 0, v72
    v_add_f32 v72, v247, v72
    v_cvt_pk_bf16_f32 v72, v72, 0
    s_mov_b64 exec, 0xffff
    buffer_store_short v72, v5, s[52:55], s85 offen
    s_cmp_lg_u32 s91, 0
    s_cbranch_scc1 L_end
    v_mov_b32 v74, s100
    s_mov_b32 s3, 0x800
    s_mov_b64 exec, 1
    buffer_store_dword v74, off, s[44:47], s3
    s_branch L_end
L_sB_s:
    s_nop 4
    buffer_store_dwordx4 v[80:83], v12, s[44:47], s85 offen sc1
    s_nop 1
    s_branch L_sB_j
L_sC_s:
    s_nop 4
    buffer_store_dwordx4 v[76:79], v18, s[44:47], s85 offen sc1
    s_nop 1
    s_branch L_sC_j
L_end:
    s_nop 4
L_exit:
    s_endpgm
L_codeend:
.section .rodata,"a"
.p2align 6
.amdhsa_kernel adaLN_cond__mha_block_cached__glu_gated_swiglu__decode_kernel
  .amdhsa_next_free_vgpr 248
  .amdhsa_next_free_sgpr 102
  .amdhsa_accum_offset 248
  .amdhsa_group_segment_fixed_size 0
  .amdhsa_kernarg_size 112
  .amdhsa_user_sgpr_count 2
  .amdhsa_user_sgpr_kernarg_segment_ptr 1
  .amdhsa_system_sgpr_workgroup_id_x 1
  .amdhsa_float_denorm_mode_32 3
.end_amdhsa_kernel
```
